```python
import torch

def _softmax(x, axis=-1):
    return torch.softmax(x, dim=axis)
def _gelu(x):
    return torch.nn.functional.gelu(x, approximate="tanh")
def _silu(x):
    return torch.nn.functional.silu(x)
def _sigmoid(x):
    return torch.sigmoid(x)
def _layernorm(x, axis=-1, eps=1e-5):
    m = x.mean(dim=axis, keepdim=True)
    v = x.var(dim=axis, keepdim=True, unbiased=False)
    return (x - m) / torch.sqrt(v + eps)
def _scatter_add(tgt, idx, src, axis=0):
    return tgt.clone().index_add_(axis, idx, src)
def _segment_sum(src, seg, n):
    out = torch.zeros((n,) + src.shape[1:], dtype=src.dtype)
    return out.index_add_(0, seg, src)
def _pad(x, pw):
    flat = tuple(v for pair in reversed(pw) for v in pair)
    return torch.nn.functional.pad(x, flat)

kernel_name = 'interleave_layers__mha_block_cached__glu_gated_swiglu__decode'

def setup_inputs():

    _w = (lambda a: (lambda t: t.to(torch.bfloat16) if t.is_floating_point() else t)(torch.as_tensor(a)))
    def _A_setup():
        B, Sq, D = 1, 1, 448
        H, Sk, Dh = 16, 32768, 256
        return {
            "x": _w((lambda *s: torch.randn(*s, dtype=torch.bfloat16) * 0.05)(B, Sq, D)),
            "k_cache": _w((lambda *s: torch.randn(*s, dtype=torch.bfloat16) * 1.6)(B, H, Sk, Dh)),
            "v_cache": _w((lambda *s: torch.randn(*s, dtype=torch.bfloat16) * 0.8)(B, H, Sk, Dh)),
            "wq": _w((lambda *s: torch.randn(*s, dtype=torch.bfloat16) * 1.6)(D, H * Dh) * (D ** -0.5)),
            "wo": _w((lambda *s: torch.randn(*s, dtype=torch.bfloat16) * 0.8)(H * Dh, D) * ((H * Dh) ** -0.5)),
        }
    _A_in = _A_setup()

    def _B_setup():
        B, S, D, F = 1, 1, 448, 1792
        return {
            "x": _w((lambda *s: torch.randn(*s, dtype=torch.bfloat16) * 0.05)(B, S, D)),
            "w1": _w((lambda *s: torch.randn(*s, dtype=torch.bfloat16) * 0.4)(D, F) * (2.0 / D) ** 0.5),
            "w3": _w((lambda *s: torch.randn(*s, dtype=torch.bfloat16) * 0.4)(D, F) * (2.0 / D) ** 0.5),
            "w2": _w((lambda *s: torch.randn(*s, dtype=torch.bfloat16) * 0.4)(F, D) * (2.0 / F) ** 0.5),
        }
    _B_in = _B_setup()

    return {
        "A_x": _A_in["x"],
        "A_k_cache": _A_in["k_cache"],
        "A_v_cache": _A_in["v_cache"],
        "A_wq": _A_in["wq"],
        "A_wo": _A_in["wo"],
        "B_x": _B_in["x"],
        "B_w1": _B_in["w1"],
        "B_w3": _B_in["w3"],
        "B_w2": _B_in["w2"],
    }

def reference(A_x, A_k_cache, A_v_cache, A_wq, A_wo, B_x, B_w1, B_w3, B_w2):
    def _A_ref(x, k_cache, v_cache, wq, wo):
        B, Sq, D = x.shape
        H, Dh = 16, 256
        q = (lambda x, *d: x.permute(*d))((x @ wq).reshape(B, Sq, H, Dh), 0, 2, 1, 3)
        scores = torch.einsum("bhqd,bhkd->bhqk", q, k_cache) * (Dh ** -0.5)
        p = _softmax(scores, axis=-1)
        o = torch.einsum("bhqk,bhkd->bhqd", p, v_cache)
        return (lambda x, *d: x.permute(*d))(o, 0, 2, 1, 3).reshape(B, Sq, H * Dh) @ wo

    def _B_ref(x, w1, w3, w2):
        gate = torch.einsum("bsd,df->bsf", x, w1)
        up = torch.einsum("bsd,df->bsf", x, w3)
        h = _silu(gate) * up
        out = torch.einsum("bsf,fd->bsd", h, w2)
        return out

    x = A_x
    x = x + _A_ref(_layernorm(x, axis=-1), A_k_cache, A_v_cache, A_wq, A_wo)
    x = x + _B_ref(_layernorm(x, axis=-1), B_w1, B_w3, B_w2)
    x = x + _A_ref(_layernorm(x, axis=-1), A_k_cache, A_v_cache, A_wq, A_wo)
    x = x + _B_ref(_layernorm(x, axis=-1), B_w1, B_w3, B_w2)
    return x
```

```asm
; @launch grid=(256,1,1) block=(256,1,1) lds=163840
.amdgcn_target "amdgcn-amd-amdhsa--gfx950"
.text
.globl interleave_layers__mha_block_cached__glu_gated_swiglu__decode_kernel
.p2align 8
.type interleave_layers__mha_block_cached__glu_gated_swiglu__decode_kernel,@function
interleave_layers__mha_block_cached__glu_gated_swiglu__decode_kernel:
    s_cmp_ge_u32 s2, 256
    s_cbranch_scc1 END
    s_load_dwordx16 s[64:79], s[0:1], 0
    s_load_dwordx8 s[80:87], s[0:1], 64
    v_lshrrev_b32 v1, 6, v0
    s_nop 0
    v_readfirstlane_b32 s3, v1
    s_lshr_b32 s57, s2, 6
    s_bfe_u32 s7, s2, 0x30003
    s_and_b32 s58, s2, 7
    s_lshr_b32 s6, s58, 2
    s_bfe_u32 s57, s58, 0x10001
    s_lshr_b32 s4, s2, 5
    s_lshl_b32 s4, s4, 1
    s_add_u32 s4, s4, s57
    s_and_b32 s57, s58, 1
    s_lshl_b32 s57, s57, 2
    s_bfe_u32 s7, s2, 0x20003
    s_add_u32 s7, s7, s57
    s_lshl_b32 s5, s6, 3
    s_add_u32 s5, s5, s7
    s_lshl_b32 s57, s7, 2
    s_add_u32 s57, s57, s3
    s_lshl_b32 s57, s57, 14
    s_lshl_b32 s58, s6, 13
    s_add_u32 s52, s57, s58
    s_mul_i32 s54, s4, 14
    s_add_u32 s54, s54, s5
    s_cmp_lt_u32 s5, 14
    s_cselect_b32 s54, s54, 255
    s_lshl_b32 s57, s5, 2
    s_add_u32 s57, s57, s3
    s_lshl_b32 s52, s57, 13
    s_lshl_b32 s55, s3, 15
    s_mov_b32 s53, 0x3db8aa3b
    v_and_b32 v30, 63, v0
    v_lshrrev_b32 v32, 4, v30
    v_bfe_u32 v33, v30, 2, 2
    v_and_b32 v34, 3, v30
    v_and_b32 v35, 15, v30
    v_lshlrev_b32 v1, 9, v33
    v_lshl_add_u32 v1, v32, 6, v1
    v_lshl_add_u32 v1, v34, 4, v1
    v_lshlrev_b32 v2, 9, v32
    v_lshl_add_u32 v2, v35, 4, v2
    v_lshlrev_b32 v3, 4, v30
    v_add_u32 v3, s55, v3
    v_and_b32 v36, 1, v35
    v_cmp_eq_u32 vcc, 1, v36
    v_mov_b32 v37, 0x0000ffff
    v_mov_b32 v38, 0xffff0000
    v_cndmask_b32 v36, v37, v38, vcc
    v_lshrrev_b32 v37, 1, v35
    v_cmp_eq_u32 vcc, 0, v37
    s_nop 1
    v_cndmask_b32 v4, 0, v36, vcc
    v_cmp_eq_u32 vcc, 1, v37
    s_nop 1
    v_cndmask_b32 v5, 0, v36, vcc
    v_cmp_eq_u32 vcc, 2, v37
    s_nop 1
    v_cndmask_b32 v6, 0, v36, vcc
    v_cmp_eq_u32 vcc, 3, v37
    s_nop 1
    v_cndmask_b32 v7, 0, v36, vcc
    s_getpc_b64 s[62:63]
GPC0:
    s_add_u32 s48, s62, SLOW-GPC0
    s_addc_u32 s49, s63, 0
    s_waitcnt lgkmcnt(0)
    s_mov_b64 s[24:25], s[64:65]
    s_mov_b64 s[26:27], s[70:71]
    s_mov_b64 s[28:29], s[72:73]
    s_mov_b64 s[30:31], s[76:77]
    s_mov_b64 s[32:33], s[78:79]
    s_mov_b64 s[34:35], s[80:81]
    s_mov_b64 s[36:37], s[82:83]
    s_mov_b64 s[38:39], s[84:85]
    s_lshl_b32 s57, s4, 24
    s_add_u32 s8, s66, s57
    s_addc_u32 s9, s67, 0
    s_and_b32 s9, s9, 0xffff
    s_mov_b32 s10, 16777216
    s_mov_b32 s11, 0x20000
    s_add_u32 s12, s68, s57
    s_addc_u32 s13, s69, 0
    s_and_b32 s13, s13, 0xffff
    s_mov_b32 s14, 16777216
    s_mov_b32 s15, 0x20000
    s_mov_b32 s16, s86
    s_and_b32 s17, s87, 0xffff
    s_mov_b32 s18, 3371008
    s_mov_b32 s19, 0x20000
    s_add_u32 s72, s62, QK0-GPC0
    s_addc_u32 s73, s63, 0
    s_add_u32 s74, s62, QK1-GPC0
    s_addc_u32 s75, s63, 0
    s_add_u32 s76, s62, PV0-GPC0
    s_addc_u32 s77, s63, 0
    s_add_u32 s78, s62, PV1-GPC0
    s_addc_u32 s79, s63, 0
    s_add_u32 s80, s62, HELDA-GPC0
    s_addc_u32 s81, s63, 0
    s_add_u32 s82, s62, HELDB-GPC0
    s_addc_u32 s83, s63, 0
    s_add_u32 s84, s62, MID-GPC0
    s_addc_u32 s85, s63, 0
    s_lshl_b32 s57, s7, 2
    s_add_u32 s57, s57, s3
    s_lshl_b32 s57, s57, 14
    s_lshl_b32 s58, s6, 13
    s_add_u32 s86, s57, s58
    s_xor_b32 s58, s58, 8192
    s_add_u32 s87, s57, s58
    s_mul_i32 s88, s4, 94208
    s_add_u32 s88, s88, 655360
    s_mov_b32 s68, -1
    v_mov_b32 v32, -1
    v_mov_b32 v33, -1
    v_lshlrev_b32 v34, 2, v0
    s_lshl_b32 s46, s4, 4
    s_add_u32 s46, s46, s5
    s_mul_i32 s46, s46, 1152
    s_add_u32 s57, s46, 0
    buffer_store_dword v32, v34, s[16:19], s57 offen sc1
    s_add_u32 s57, s46, 294912
    buffer_store_dword v32, v34, s[16:19], s57 offen sc1
    v_and_b32 v39, 63, v0
    v_lshrrev_b32 v40, 2, v39
    v_lshlrev_b32 v40, 12, v40
    v_and_b32 v41, 3, v39
    v_lshl_add_u32 v40, v41, 4, v40
    s_lshr_b32 s57, s86, 7
    s_add_u32 s57, s57, s88
    s_add_u32 s57, s57, 28672
    v_mov_b32 v42, -1
    v_mov_b32 v43, -1
    v_mov_b32 v44, -1
    v_mov_b32 v45, -1
    buffer_store_dwordx4 v[42:45], v40, s[16:19], s57 offen sc1
    v_cmp_gt_u32 vcc, 28, v39
    s_and_saveexec_b64 s[60:61], vcc
    s_add_u32 s57, s57, 65536
    buffer_store_dwordx4 v[42:45], v40, s[16:19], s57 offen sc1
    s_mov_b64 exec, s[60:61]
    s_cmp_lg_u32 s3, 0
    s_cbranch_scc1 CL_1
    v_cmp_gt_u32 vcc, 2, v0
    s_and_saveexec_b64 s[60:61], vcc
    s_add_u32 s57, s46, 1024
    buffer_store_dword v32, v34, s[16:19], s57 offen sc1
    s_add_u32 s57, s46, 295936
    buffer_store_dword v32, v34, s[16:19], s57 offen sc1
    s_mov_b64 exec, s[60:61]
    v_cmp_gt_u32 vcc, 32, v0
    s_and_saveexec_b64 s[60:61], vcc
    s_mul_i32 s57, s4, 1792
    s_min_u32 s58, s5, 13
    s_lshl_b32 s58, s58, 7
    s_add_u32 s58, s58, s57
    s_add_u32 s57, s58, 589824
    buffer_store_dword v32, v34, s[16:19], s57 offen sc1
    s_add_u32 s57, s58, 618496
    buffer_store_dword v32, v34, s[16:19], s57 offen sc1
    s_mov_b64 exec, s[60:61]
    v_cmp_gt_u32 vcc, 4, v0
    s_and_saveexec_b64 s[60:61], vcc
    s_min_u32 s58, s54, 223
    s_lshl_b32 s58, s58, 4
    s_add_u32 s57, s58, 647168
    buffer_store_dword v32, v34, s[16:19], s57 offen sc1
    s_add_u32 s57, s58, 650752
    buffer_store_dword v32, v34, s[16:19], s57 offen sc1
    s_mov_b64 exec, s[60:61]
    v_cmp_gt_u32 vcc, 8, v0
    s_and_saveexec_b64 s[60:61], vcc
    s_min_u32 s58, s54, 223
    s_and_b32 s57, s58, 3
    s_mul_i32 s57, s57, 1792
    s_lshr_b32 s58, s58, 2
    s_lshl_b32 s58, s58, 5
    s_add_u32 s57, s57, s58
    s_add_u32 s57, s57, 654336
    buffer_store_dword v32, v34, s[16:19], s57 offen sc1
    s_lshl_b32 s57, s4, 9
    s_lshl_b32 s58, s5, 5
    s_add_u32 s57, s57, s58
    s_add_u32 s57, s57, 661504
    buffer_store_dword v32, v34, s[16:19], s57 offen sc1
    s_add_u32 s57, s57, 8192
    buffer_store_dword v32, v34, s[16:19], s57 offen sc1
    s_mov_b64 exec, s[60:61]
    v_cmp_eq_u32 vcc, 0, v0
    s_and_saveexec_b64 s[60:61], vcc
    s_lshl_b32 s57, s4, 6
    s_lshl_b32 s58, s5, 2
    s_add_u32 s57, s57, s58
    s_add_u32 s57, s57, 677888
    buffer_store_dword v32, v34, s[16:19], s57 offen sc1
    s_mov_b64 exec, s[60:61]
CL_1:
    s_mov_b32 s20, s24
    s_and_b32 s21, s25, 0xffff
    s_mov_b32 s22, 896
    s_mov_b32 s23, 0x20000
    v_and_b32 v30, 63, v0
    v_lshlrev_b32 v36, 2, v30
    buffer_load_dword v56, v36, s[20:23], 0 offen offset:0
    buffer_load_dword v57, v36, s[20:23], 0 offen offset:256
    buffer_load_dword v58, v36, s[20:23], 0 offen offset:512
    buffer_load_dword v59, v36, s[20:23], 0 offen offset:768
    v_lshlrev_b32 v36, 2, v0
    buffer_load_dword v31, v36, s[20:23], 0 offen
    s_lshl_b32 s46, s3, 7
    s_mul_i32 s46, s46, 8192
    s_lshl_b32 s57, s4, 9
    s_add_u32 s46, s46, s57
    s_lshl_b32 s57, s5, 5
    s_add_u32 s46, s46, s57
    s_lshl_b32 s47, s3, 12
    s_add_u32 s47, s47, 147456
    s_mov_b32 s20, s26
    s_and_b32 s21, s27, 0xffff
    s_mov_b32 s22, 3670016
    s_mov_b32 s23, 0x20000
    v_and_b32 v30, 63, v0
    v_lshrrev_b32 v28, 1, v30
    v_and_b32 v30, 1, v30
    v_lshlrev_b32 v30, 4, v30
    s_mov_b32 s57, 8192
    v_mul_lo_u32 v28, v28, s57
    v_add_u32 v30, v30, v28
    s_add_u32 m0, s47, 0
    s_add_u32 s57, s46, 0
    buffer_load_dwordx4 v30, s[20:23], s57 offen lds
    s_add_u32 m0, s47, 1024
    s_add_u32 s57, s46, 262144
    buffer_load_dwordx4 v30, s[20:23], s57 offen lds
    s_cmp_eq_u32 s3, 3
    s_cbranch_scc1 DS_2
    s_add_u32 m0, s47, 2048
    s_add_u32 s57, s46, 524288
    buffer_load_dwordx4 v30, s[20:23], s57 offen lds
    s_add_u32 m0, s47, 3072
    s_add_u32 s57, s46, 786432
    buffer_load_dwordx4 v30, s[20:23], s57 offen lds
DS_2:
    s_sub_u32 s20, s62, GPC0-interleave_layers__mha_block_cached__glu_gated_swiglu__decode_kernel
    s_subb_u32 s21, s63, 0
    s_and_b32 s21, s21, 0xffff
    s_mov_b32 s22, CODE_END-interleave_layers__mha_block_cached__glu_gated_swiglu__decode_kernel
    s_mov_b32 s23, 0x20000
    v_lshlrev_b32 v32, 7, v0
    buffer_load_dword v49, v32, s[20:23], 0 offen
    s_mov_b32 s58, 0x21043210
    s_mov_b32 s59, 0x4321043
    s_lshl_b32 s57, s4, 2
    s_lshr_b64 s[58:59], s[58:59], s57
    s_and_b32 s58, s58, 15
    s_mov_b32 s66, 0x9ce7380
    s_mov_b32 s67, 0xce73980
    s_cmp_eq_u32 s58, 1
    s_cselect_b32 s66, 0xce73980, s66
    s_cselect_b32 s67, 0xe739d80, s67
    s_cmp_eq_u32 s58, 2
    s_cselect_b32 s66, 0xe739d80, s66
    s_cselect_b32 s67, 0xf39cf80, s67
    s_cmp_eq_u32 s58, 3
    s_cselect_b32 s66, 0xf39cf80, s66
    s_cselect_b32 s67, 0xb9ce780, s67
    s_cmp_eq_u32 s58, 4
    s_cselect_b32 s66, 0xb9ce780, s66
    s_cselect_b32 s67, 0x9ce7380, s67
    s_add_u32 s44, s52, 3670016
    s_add_u32 s45, s44, 4096
    buffer_load_dwordx4 v[64:67], v1, s[8:11], s44 offen offset:0
    buffer_load_dwordx4 v[68:71], v1, s[8:11], s44 offen offset:256
    buffer_load_dwordx4 v[72:75], v1, s[8:11], s44 offen offset:2048
    buffer_load_dwordx4 v[76:79], v1, s[8:11], s44 offen offset:2304
    buffer_load_dwordx4 v[80:83], v1, s[8:11], s45 offen offset:0
    buffer_load_dwordx4 v[84:87], v1, s[8:11], s45 offen offset:256
    buffer_load_dwordx4 v[88:91], v1, s[8:11], s45 offen offset:2048
    buffer_load_dwordx4 v[92:95], v1, s[8:11], s45 offen offset:2304
    s_add_u32 s44, s52, 3670016
    s_add_u32 s45, s44, 4096
    buffer_load_dwordx4 v[96:99], v2, s[12:15], s44 offen offset:0
    buffer_load_dwordx4 v[100:103], v2, s[12:15], s44 offen offset:256
    buffer_load_dwordx4 v[104:107], v2, s[12:15], s44 offen offset:2048
    buffer_load_dwordx4 v[108:111], v2, s[12:15], s44 offen offset:2304
    buffer_load_dwordx4 v[112:115], v2, s[12:15], s45 offen offset:0
    buffer_load_dwordx4 v[116:119], v2, s[12:15], s45 offen offset:256
    buffer_load_dwordx4 v[120:123], v2, s[12:15], s45 offen offset:2048
    buffer_load_dwordx4 v[124:127], v2, s[12:15], s45 offen offset:2304
    s_add_u32 s44, s52, 4194304
    s_add_u32 s45, s44, 4096
    buffer_load_dwordx4 v[128:131], v1, s[8:11], s44 offen offset:0
    buffer_load_dwordx4 v[132:135], v1, s[8:11], s44 offen offset:256
    buffer_load_dwordx4 v[136:139], v1, s[8:11], s44 offen offset:2048
    buffer_load_dwordx4 v[140:143], v1, s[8:11], s44 offen offset:2304
    buffer_load_dwordx4 v[144:147], v1, s[8:11], s45 offen offset:0
    buffer_load_dwordx4 v[148:151], v1, s[8:11], s45 offen offset:256
    buffer_load_dwordx4 v[152:155], v1, s[8:11], s45 offen offset:2048
    buffer_load_dwordx4 v[156:159], v1, s[8:11], s45 offen offset:2304
    s_waitcnt vmcnt(24)
    s_lshl_b32 s47, s3, 12
    s_add_u32 s47, s47, 147456
    v_and_b32 v30, 63, v0
    v_lshrrev_b32 v28, 4, v30
    v_bfe_u32 v27, v30, 2, 2
    v_lshl_add_u32 v27, v28, 3, v27
    v_mul_u32_u24 v27, 32, v27
    v_and_b32 v28, 3, v30
    v_lshl_add_u32 v27, v28, 3, v27
    v_add_u32 v27, s47, v27
    v_lshlrev_b32 v40, 16, v56
    v_and_b32 v41, 0xffff0000, v56
    v_lshlrev_b32 v42, 16, v57
    v_and_b32 v43, 0xffff0000, v57
    v_lshlrev_b32 v44, 16, v58
    v_and_b32 v45, 0xffff0000, v58
    v_lshlrev_b32 v46, 16, v59
    v_and_b32 v47, 0xffff0000, v59
    ds_read_b64_tr_b16 v[48:49], v27 offset:0
    ds_read_b64_tr_b16 v[50:51], v27 offset:128
    ds_read_b64_tr_b16 v[52:53], v27 offset:1024
    ds_read_b64_tr_b16 v[54:55], v27 offset:1152
    ds_read_b64_tr_b16 v[56:57], v27 offset:2048
    ds_read_b64_tr_b16 v[58:59], v27 offset:2176
    ds_read_b64_tr_b16 v[60:61], v27 offset:3072
    ds_read_b64_tr_b16 v[62:63], v27 offset:3200
    v_add_f32 v24, v40, v41
    v_add_f32 v24, v24, v42
    v_add_f32 v24, v24, v43
    v_add_f32 v24, v24, v44
    v_add_f32 v24, v24, v45
    v_add_f32 v24, v24, v46
    v_add_f32 v24, v24, v47
    s_nop 1
    v_add_f32_dpp v24, v24, v24 quad_perm:[1,0,3,2] row_mask:0xf bank_mask:0xf
    s_nop 1
    v_add_f32_dpp v24, v24, v24 quad_perm:[2,3,0,1] row_mask:0xf bank_mask:0xf
    s_nop 1
    v_add_f32_dpp v24, v24, v24 row_half_mirror row_mask:0xf bank_mask:0xf
    s_nop 1
    v_add_f32_dpp v24, v24, v24 row_mirror row_mask:0xf bank_mask:0xf
    s_nop 1
    v_readlane_b32 s40, v24, 0
    v_readlane_b32 s41, v24, 16
    v_readlane_b32 s42, v24, 32
    v_readlane_b32 s43, v24, 48
    s_nop 1
    v_mov_b32 v24, s40
    v_add_f32 v24, s41, v24
    v_add_f32 v24, s42, v24
    v_add_f32 v24, s43, v24
    v_mul_f32 v24, 0x3b124925, v24
    v_sub_f32 v40, v40, v24
    v_sub_f32 v41, v41, v24
    v_sub_f32 v42, v42, v24
    v_sub_f32 v43, v43, v24
    v_sub_f32 v44, v44, v24
    v_sub_f32 v45, v45, v24
    v_sub_f32 v46, v46, v24
    v_sub_f32 v47, v47, v24
    v_and_b32 v30, 63, v0
    v_cmp_gt_u32 vcc, 32, v30
    s_nop 1
    v_cndmask_b32 v46, 0, v46, vcc
    v_cndmask_b32 v47, 0, v47, vcc
    v_mul_f32 v25, v40, v40
    v_fmac_f32 v25, v41, v41
    v_fmac_f32 v25, v42, v42
    v_fmac_f32 v25, v43, v43
    v_fmac_f32 v25, v44, v44
    v_fmac_f32 v25, v45, v45
    v_fmac_f32 v25, v46, v46
    v_fmac_f32 v25, v47, v47
    s_nop 1
    v_add_f32_dpp v25, v25, v25 quad_perm:[1,0,3,2] row_mask:0xf bank_mask:0xf
    s_nop 1
    v_add_f32_dpp v25, v25, v25 quad_perm:[2,3,0,1] row_mask:0xf bank_mask:0xf
    s_nop 1
    v_add_f32_dpp v25, v25, v25 row_half_mirror row_mask:0xf bank_mask:0xf
    s_nop 1
    v_add_f32_dpp v25, v25, v25 row_mirror row_mask:0xf bank_mask:0xf
    s_nop 1
    v_readlane_b32 s40, v25, 0
    v_readlane_b32 s41, v25, 16
    v_readlane_b32 s42, v25, 32
    v_readlane_b32 s43, v25, 48
    s_nop 1
    v_mov_b32 v25, s40
    v_add_f32 v25, s41, v25
    v_add_f32 v25, s42, v25
    v_add_f32 v25, s43, v25
    v_mul_f32 v25, 0x3b124925, v25
    v_cvt_pk_bf16_f32 v24, v24, v24
    v_and_b32 v24, 0xffff0000, v24
    v_cvt_pk_bf16_f32 v25, v25, v25
    v_and_b32 v25, 0xffff0000, v25
    v_add_f32 v25, 0x3727c5ac, v25
    v_cvt_pk_bf16_f32 v25, v25, v25
    v_and_b32 v25, 0xffff0000, v25
    v_sqrt_f32 v25, v25
    s_nop 0
    v_cvt_pk_bf16_f32 v25, v25, v25
    v_and_b32 v25, 0xffff0000, v25
    v_rcp_f32 v25, v25
    s_nop 0
    v_lshlrev_b32 v32, 16, v31
    v_and_b32 v33, 0xffff0000, v31
    v_sub_f32 v32, v32, v24
    v_cvt_pk_bf16_f32 v32, v32, v32
    v_and_b32 v32, 0xffff0000, v32
    v_mul_f32 v32, v32, v25
    v_sub_f32 v33, v33, v24
    v_cvt_pk_bf16_f32 v33, v33, v33
    v_and_b32 v33, 0xffff0000, v33
    v_mul_f32 v33, v33, v25
    v_cvt_pk_bf16_f32 v32, v32, v33
    v_cmp_gt_u32 vcc, 224, v0
    v_lshlrev_b32 v26, 2, v0
    v_add_u32 v26, 161792, v26
    v_cndmask_b32 v32, 0, v32, vcc
    ds_write_b32 v26, v32
    v_bfe_u32 v27, v0, 4, 2
    v_lshlrev_b32 v27, 4, v27
    s_lshl_b32 s57, s3, 8
    s_add_u32 s57, s57, 161792
    v_add_u32 v27, s57, v27
    v_and_b32 v28, 15, v0
    v_lshlrev_b32 v28, 3, v28
    s_lshl_b32 s57, s3, 7
    s_add_u32 s57, s57, 162816
    v_add_u32 v28, s57, v28
    s_waitcnt lgkmcnt(0)
    v_mov_b32 v16, 0
    v_mov_b32 v17, 0
    v_mov_b32 v18, 0
    v_mov_b32 v19, 0
    ds_read_b128 v[32:35], v27 offset:0
    ds_read_b128 v[36:39], v27 offset:64
    ds_read_b128 v[40:43], v27 offset:128
    ds_read_b128 v[44:47], v27 offset:192
    s_waitcnt lgkmcnt(3)
    v_mfma_f32_16x16x32_bf16 v[16:19], v[32:35], v[48:51], v[16:19]
    s_waitcnt lgkmcnt(2)
    v_mfma_f32_16x16x32_bf16 v[16:19], v[36:39], v[52:55], v[16:19]
    s_cmp_eq_u32 s3, 3
    s_cbranch_scc1 GK_3
    s_waitcnt lgkmcnt(1)
    v_mfma_f32_16x16x32_bf16 v[16:19], v[40:43], v[56:59], v[16:19]
    s_waitcnt lgkmcnt(0)
    v_mfma_f32_16x16x32_bf16 v[16:19], v[44:47], v[60:63], v[16:19]
GK_3:
    s_waitcnt lgkmcnt(0)
    s_nop 7
    s_mov_b64 exec, 0xffff
    ds_write_b64 v28, v[16:17]
    s_mov_b64 exec, -1
    v_mov_b32 v30, 163376
    v_mov_b32 v29, 0
    ds_write_b32 v30, v29
    s_waitcnt lgkmcnt(0)
    s_barrier
    s_cmp_lg_u32 s3, 0
    s_cbranch_scc1 Q1X_4
    v_and_b32 v30, 15, v0
    v_lshlrev_b32 v30, 3, v30
    v_add_u32 v30, 162816, v30
    ds_read_b64 v[32:33], v30 offset:0
    ds_read_b64 v[34:35], v30 offset:128
    ds_read_b64 v[36:37], v30 offset:256
    ds_read_b64 v[38:39], v30 offset:384
    s_waitcnt lgkmcnt(0)
    v_add_f32 v32, v32, v34
    v_add_f32 v36, v36, v38
    v_add_f32 v33, v33, v35
    v_add_f32 v37, v37, v39
    v_add_f32 v32, v32, v36
    v_add_f32 v33, v33, v37
    s_lshl_b32 s57, s4, 9
    s_lshl_b32 s58, s5, 5
    v_mov_b32_dpp v33, v32 quad_perm:[1,0,3,2] row_mask:0xf bank_mask:0xf
    s_add_u32 s57, s57, s58
    s_add_u32 s57, s57, 669696
    v_cvt_pk_bf16_f32 v32, v32, v33
    v_lshlrev_b32 v35, 1, v0
    s_mov_b64 exec, 0x5555
    buffer_store_dword v32, v35, s[16:19], s57 offen sc1
    s_mov_b64 exec, -1
    s_mov_b32 s57, 1
    s_atomic_add s57, s[38:39], 0
Q1X_4:
    s_add_u32 s44, s52, 4194304
    s_add_u32 s45, s44, 4096
    buffer_load_dwordx4 v[160:163], v2, s[12:15], s44 offen offset:0
    buffer_load_dwordx4 v[164:167], v2, s[12:15], s44 offen offset:256
    buffer_load_dwordx4 v[168:171], v2, s[12:15], s44 offen offset:2048
    buffer_load_dwordx4 v[172:175], v2, s[12:15], s44 offen offset:2304
    buffer_load_dwordx4 v[176:179], v2, s[12:15], s45 offen offset:0
    buffer_load_dwordx4 v[180:183], v2, s[12:15], s45 offen offset:256
    buffer_load_dwordx4 v[184:187], v2, s[12:15], s45 offen offset:2048
    buffer_load_dwordx4 v[188:191], v2, s[12:15], s45 offen offset:2304
    s_add_u32 s44, s52, 1048576
    s_add_u32 s45, s44, 4096
    buffer_load_dwordx4 a[64:67], v1, s[8:11], s44 offen offset:0 nt
    buffer_load_dwordx4 a[68:71], v1, s[8:11], s44 offen offset:256 nt
    buffer_load_dwordx4 a[72:75], v1, s[8:11], s44 offen offset:2048 nt
    buffer_load_dwordx4 a[76:79], v1, s[8:11], s44 offen offset:2304 nt
    buffer_load_dwordx4 a[80:83], v1, s[8:11], s45 offen offset:0 nt
    buffer_load_dwordx4 a[84:87], v1, s[8:11], s45 offen offset:256 nt
    buffer_load_dwordx4 a[88:91], v1, s[8:11], s45 offen offset:2048 nt
    buffer_load_dwordx4 a[92:95], v1, s[8:11], s45 offen offset:2304 nt
    s_add_u32 s44, s52, 1048576
    s_add_u32 s45, s44, 4096
    buffer_load_dwordx4 a[96:99], v2, s[12:15], s44 offen offset:0 nt
    buffer_load_dwordx4 a[100:103], v2, s[12:15], s44 offen offset:256 nt
    buffer_load_dwordx4 a[104:107], v2, s[12:15], s44 offen offset:2048 nt
    buffer_load_dwordx4 a[108:111], v2, s[12:15], s44 offen offset:2304 nt
    buffer_load_dwordx4 a[112:115], v2, s[12:15], s45 offen offset:0 nt
    buffer_load_dwordx4 a[116:119], v2, s[12:15], s45 offen offset:256 nt
    buffer_load_dwordx4 a[120:123], v2, s[12:15], s45 offen offset:2048 nt
    buffer_load_dwordx4 a[124:127], v2, s[12:15], s45 offen offset:2304 nt
    s_add_u32 s44, s52, 1572864
    s_add_u32 s45, s44, 4096
    buffer_load_dwordx4 a[128:131], v1, s[8:11], s44 offen offset:0 nt
    buffer_load_dwordx4 a[132:135], v1, s[8:11], s44 offen offset:256 nt
    buffer_load_dwordx4 a[136:139], v1, s[8:11], s44 offen offset:2048 nt
    buffer_load_dwordx4 a[140:143], v1, s[8:11], s44 offen offset:2304 nt
    buffer_load_dwordx4 a[144:147], v1, s[8:11], s45 offen offset:0 nt
    buffer_load_dwordx4 a[148:151], v1, s[8:11], s45 offen offset:256 nt
    s_waitcnt vmcnt(50)
    buffer_load_dwordx4 a[152:155], v1, s[8:11], s45 offen offset:2048 nt
    buffer_load_dwordx4 a[156:159], v1, s[8:11], s45 offen offset:2304 nt
    s_add_u32 s44, s52, 1572864
    s_add_u32 s45, s44, 4096
    buffer_load_dwordx4 a[160:163], v2, s[12:15], s44 offen offset:0 nt
    buffer_load_dwordx4 a[164:167], v2, s[12:15], s44 offen offset:256 nt
    s_waitcnt vmcnt(50)
    buffer_load_dwordx4 a[168:171], v2, s[12:15], s44 offen offset:2048 nt
    buffer_load_dwordx4 a[172:175], v2, s[12:15], s44 offen offset:2304 nt
    buffer_load_dwordx4 a[176:179], v2, s[12:15], s45 offen offset:0 nt
    buffer_load_dwordx4 a[180:183], v2, s[12:15], s45 offen offset:256 nt
    s_waitcnt vmcnt(50)
    buffer_load_dwordx4 a[184:187], v2, s[12:15], s45 offen offset:2048 nt
    buffer_load_dwordx4 a[188:191], v2, s[12:15], s45 offen offset:2304 nt
    s_add_u32 s44, s52, 2097152
    s_add_u32 s45, s44, 4096
    buffer_load_dwordx4 a[192:195], v1, s[8:11], s44 offen offset:0 nt
    buffer_load_dwordx4 a[196:199], v1, s[8:11], s44 offen offset:256 nt
    s_waitcnt vmcnt(50)
    buffer_load_dwordx4 a[200:203], v1, s[8:11], s44 offen offset:2048 nt
    buffer_load_dwordx4 a[204:207], v1, s[8:11], s44 offen offset:2304 nt
    buffer_load_dwordx4 a[208:211], v1, s[8:11], s45 offen offset:0 nt
    buffer_load_dwordx4 a[212:215], v1, s[8:11], s45 offen offset:256 nt
    s_waitcnt vmcnt(50)
    buffer_load_dwordx4 a[216:219], v1, s[8:11], s45 offen offset:2048 nt
    buffer_load_dwordx4 a[220:223], v1, s[8:11], s45 offen offset:2304 nt
    s_add_u32 s44, s52, 2097152
    s_add_u32 s45, s44, 4096
    buffer_load_dwordx4 a[224:227], v2, s[12:15], s44 offen offset:0 nt
    buffer_load_dwordx4 a[228:231], v2, s[12:15], s44 offen offset:256 nt
    s_waitcnt vmcnt(50)
    buffer_load_dwordx4 a[232:235], v2, s[12:15], s44 offen offset:2048 nt
    buffer_load_dwordx4 a[236:239], v2, s[12:15], s44 offen offset:2304 nt
    buffer_load_dwordx4 a[240:243], v2, s[12:15], s45 offen offset:0 nt
    buffer_load_dwordx4 a[244:247], v2, s[12:15], s45 offen offset:256 nt
    s_waitcnt vmcnt(50)
    buffer_load_dwordx4 a[248:251], v2, s[12:15], s45 offen offset:2048 nt
    buffer_load_dwordx4 a[252:255], v2, s[12:15], s45 offen offset:2304 nt
    s_add_u32 s44, s52, 2621440
    s_add_u32 s45, s44, 4096
    s_add_u32 m0, s55, 0
    s_add_u32 s45, s44, 0
    buffer_load_dwordx4 v1, s[8:11], s45 offen nt lds
    s_add_u32 m0, s55, 1024
    s_add_u32 s45, s44, 256
    buffer_load_dwordx4 v1, s[8:11], s45 offen nt lds
    s_add_u32 m0, s55, 2048
    s_add_u32 s45, s44, 2048
    s_waitcnt vmcnt(50)
    buffer_load_dwordx4 v1, s[8:11], s45 offen nt lds
    s_add_u32 m0, s55, 3072
    s_add_u32 s45, s44, 2304
    buffer_load_dwordx4 v1, s[8:11], s45 offen nt lds
    s_add_u32 m0, s55, 4096
    s_add_u32 s45, s44, 4096
    buffer_load_dwordx4 v1, s[8:11], s45 offen nt lds
    s_add_u32 m0, s55, 5120
    s_add_u32 s45, s44, 4352
    buffer_load_dwordx4 v1, s[8:11], s45 offen nt lds
    s_add_u32 m0, s55, 6144
    s_add_u32 s45, s44, 6144
    s_waitcnt vmcnt(50)
    buffer_load_dwordx4 v1, s[8:11], s45 offen nt lds
    s_add_u32 m0, s55, 7168
    s_add_u32 s45, s44, 6400
    buffer_load_dwordx4 v1, s[8:11], s45 offen nt lds
    s_load_dword s65, s[38:39], 0
    s_add_u32 s44, s52, 2621440
    s_add_u32 s45, s44, 4096
    s_add_u32 m0, s55, 8192
    s_add_u32 s45, s44, 0
    buffer_load_dwordx4 v2, s[12:15], s45 offen nt lds
    s_add_u32 m0, s55, 9216
    s_add_u32 s45, s44, 256
    buffer_load_dwordx4 v2, s[12:15], s45 offen nt lds
    s_add_u32 m0, s55, 10240
    s_add_u32 s45, s44, 2048
    s_waitcnt vmcnt(50)
    buffer_load_dwordx4 v2, s[12:15], s45 offen nt lds
    s_add_u32 m0, s55, 11264
    s_add_u32 s45, s44, 2304
    buffer_load_dwordx4 v2, s[12:15], s45 offen nt lds
    s_add_u32 m0, s55, 12288
    s_add_u32 s45, s44, 4096
    buffer_load_dwordx4 v2, s[12:15], s45 offen nt lds
    s_add_u32 m0, s55, 13312
    s_add_u32 s45, s44, 4352
    buffer_load_dwordx4 v2, s[12:15], s45 offen nt lds
    s_add_u32 m0, s55, 14336
    s_add_u32 s45, s44, 6144
    s_waitcnt vmcnt(50)
    buffer_load_dwordx4 v2, s[12:15], s45 offen nt lds
    s_add_u32 m0, s55, 15360
    s_add_u32 s45, s44, 6400
    buffer_load_dwordx4 v2, s[12:15], s45 offen nt lds
    s_waitcnt lgkmcnt(0)
    s_cmp_ge_u32 s65, 256
    s_cbranch_scc1 CD_6
    s_mov_b32 s56, 0
CC_5:
    s_mov_b32 s57, 0
    s_atomic_add s57, s[38:39], 0 glc
    s_waitcnt lgkmcnt(0)
    s_cmp_ge_u32 s57, 256
    s_cbranch_scc1 CD_6
    s_add_u32 s56, s56, 1
    s_cmp_lt_u32 s56, 65536
    s_cbranch_scc1 CC_5
CD_6:
    v_and_b32 v30, 63, v0
    v_lshrrev_b32 v32, 4, v30
    v_lshlrev_b32 v32, 2, v32
    v_and_b32 v30, 3, v30
    v_add_u32 v32, v32, v30
    v_lshlrev_b32 v32, 4, v32
    s_lshl_b32 s46, s4, 9
    s_add_u32 s46, s46, 669696
    buffer_load_dwordx4 v[8:11], v32, s[16:19], s46 offen sc1
    buffer_load_dwordx4 v[12:15], v32, s[16:19], s46 offen offset:256 sc1
    s_add_u32 s44, s52, 3145728
    s_add_u32 s45, s44, 4096
    s_add_u32 m0, s55, 16384
    s_add_u32 s45, s44, 0
    s_waitcnt vmcnt(50)
    buffer_load_dwordx4 v1, s[8:11], s45 offen nt lds
    s_add_u32 m0, s55, 17408
    s_add_u32 s45, s44, 256
    buffer_load_dwordx4 v1, s[8:11], s45 offen nt lds
    s_add_u32 m0, s55, 18432
    s_add_u32 s45, s44, 2048
    buffer_load_dwordx4 v1, s[8:11], s45 offen nt lds
    s_add_u32 m0, s55, 19456
    s_add_u32 s45, s44, 2304
    buffer_load_dwordx4 v1, s[8:11], s45 offen nt lds
    s_add_u32 m0, s55, 20480
    s_add_u32 s45, s44, 4096
    s_waitcnt vmcnt(50)
    buffer_load_dwordx4 v1, s[8:11], s45 offen nt lds
    s_add_u32 m0, s55, 21504
    s_add_u32 s45, s44, 4352
    buffer_load_dwordx4 v1, s[8:11], s45 offen nt lds
    s_add_u32 m0, s55, 22528
    s_add_u32 s45, s44, 6144
    buffer_load_dwordx4 v1, s[8:11], s45 offen nt lds
    s_add_u32 m0, s55, 23552
    s_add_u32 s45, s44, 6400
    buffer_load_dwordx4 v1, s[8:11], s45 offen nt lds
    s_add_u32 s44, s52, 3145728
    s_add_u32 s45, s44, 4096
    s_add_u32 m0, s55, 24576
    s_add_u32 s45, s44, 0
    s_waitcnt vmcnt(50)
    buffer_load_dwordx4 v2, s[12:15], s45 offen nt lds
    s_add_u32 m0, s55, 25600
    s_add_u32 s45, s44, 256
    buffer_load_dwordx4 v2, s[12:15], s45 offen nt lds
    s_add_u32 m0, s55, 26624
    s_add_u32 s45, s44, 2048
    buffer_load_dwordx4 v2, s[12:15], s45 offen nt lds
    s_add_u32 m0, s55, 27648
    s_add_u32 s45, s44, 2304
    buffer_load_dwordx4 v2, s[12:15], s45 offen nt lds
    s_add_u32 m0, s55, 28672
    s_add_u32 s45, s44, 4096
    s_waitcnt vmcnt(50)
    buffer_load_dwordx4 v2, s[12:15], s45 offen nt lds
    s_add_u32 m0, s55, 29696
    s_add_u32 s45, s44, 4352
    buffer_load_dwordx4 v2, s[12:15], s45 offen nt lds
    s_add_u32 m0, s55, 30720
    s_add_u32 s45, s44, 6144
    buffer_load_dwordx4 v2, s[12:15], s45 offen nt lds
    s_add_u32 m0, s55, 31744
    s_add_u32 s45, s44, 6400
    buffer_load_dwordx4 v2, s[12:15], s45 offen nt lds
    s_add_u32 s44, s52, 0
    s_add_u32 s45, s44, 4096
    s_waitcnt vmcnt(50)
    buffer_load_dwordx4 v[192:195], v1, s[8:11], s44 offen offset:0 nt
    buffer_load_dwordx4 v[196:199], v1, s[8:11], s44 offen offset:256 nt
    buffer_load_dwordx4 v[200:203], v1, s[8:11], s44 offen offset:2048 nt
    buffer_load_dwordx4 v[204:207], v1, s[8:11], s44 offen offset:2304 nt
    s_waitcnt vmcnt(50)
    buffer_load_dwordx4 v[208:211], v1, s[8:11], s45 offen offset:0 nt
    buffer_load_dwordx4 v[212:215], v1, s[8:11], s45 offen offset:256 nt
    buffer_load_dwordx4 v[216:219], v1, s[8:11], s45 offen offset:2048 nt
    buffer_load_dwordx4 v[220:223], v1, s[8:11], s45 offen offset:2304 nt
    s_add_u32 s44, s52, 0
    s_add_u32 s45, s44, 4096
    s_waitcnt vmcnt(50)
    buffer_load_dwordx4 v[224:227], v2, s[12:15], s44 offen offset:0 nt
    buffer_load_dwordx4 v[228:231], v2, s[12:15], s44 offen offset:256 nt
    buffer_load_dwordx4 v[232:235], v2, s[12:15], s44 offen offset:2048 nt
    buffer_load_dwordx4 v[236:239], v2, s[12:15], s44 offen offset:2304 nt
    s_waitcnt vmcnt(50)
    buffer_load_dwordx4 v[240:243], v2, s[12:15], s45 offen offset:0 nt
    buffer_load_dwordx4 v[244:247], v2, s[12:15], s45 offen offset:256 nt
    buffer_load_dwordx4 v[248:251], v2, s[12:15], s45 offen offset:2048 nt
    buffer_load_dwordx4 v[252:255], v2, s[12:15], s45 offen offset:2304 nt
    s_add_u32 s44, s52, 524288
    s_add_u32 s45, s44, 4096
    s_waitcnt vmcnt(50)
    buffer_load_dwordx4 a[0:3], v1, s[8:11], s44 offen offset:0 nt
    buffer_load_dwordx4 a[4:7], v1, s[8:11], s44 offen offset:256 nt
    buffer_load_dwordx4 a[8:11], v1, s[8:11], s44 offen offset:2048 nt
    buffer_load_dwordx4 a[12:15], v1, s[8:11], s44 offen offset:2304 nt
    s_waitcnt vmcnt(50)
    buffer_load_dwordx4 a[16:19], v1, s[8:11], s45 offen offset:0 nt
    buffer_load_dwordx4 a[20:23], v1, s[8:11], s45 offen offset:256 nt
    buffer_load_dwordx4 a[24:27], v1, s[8:11], s45 offen offset:2048 nt
    buffer_load_dwordx4 a[28:31], v1, s[8:11], s45 offen offset:2304 nt
    s_add_u32 s44, s52, 524288
    s_add_u32 s45, s44, 4096
    s_waitcnt vmcnt(50)
    buffer_load_dwordx4 a[32:35], v2, s[12:15], s44 offen offset:0 nt
    buffer_load_dwordx4 a[36:39], v2, s[12:15], s44 offen offset:256 nt
    buffer_load_dwordx4 a[40:43], v2, s[12:15], s44 offen offset:2048 nt
    buffer_load_dwordx4 a[44:47], v2, s[12:15], s44 offen offset:2304 nt
    s_waitcnt vmcnt(50)
    buffer_load_dwordx4 a[48:51], v2, s[12:15], s45 offen offset:0 nt
    buffer_load_dwordx4 a[52:55], v2, s[12:15], s45 offen offset:256 nt
    buffer_load_dwordx4 a[56:59], v2, s[12:15], s45 offen offset:2048 nt
    buffer_load_dwordx4 a[60:63], v2, s[12:15], s45 offen offset:2304 nt
    s_waitcnt vmcnt(48)
    s_mov_b32 s56, 0
Q1P_7:
    v_max_u32 v30, v8, v9
    v_max3_u32 v30, v10, v11, v30
    v_max3_u32 v30, v12, v13, v30
    v_max3_u32 v30, v14, v15, v30
    v_cmp_eq_u32 vcc, -1, v30
    s_cbranch_vccz Q1K_8
    v_and_b32 v30, 63, v0
    v_lshrrev_b32 v32, 4, v30
    v_lshlrev_b32 v32, 2, v32
    v_and_b32 v30, 3, v30
    v_add_u32 v32, v32, v30
    v_lshlrev_b32 v32, 4, v32
    s_lshl_b32 s46, s4, 9
    s_add_u32 s46, s46, 669696
    buffer_load_dwordx4 v[8:11], v32, s[16:19], s46 offen sc1
    buffer_load_dwordx4 v[12:15], v32, s[16:19], s46 offen offset:256 sc1
    s_waitcnt vmcnt(0)
    s_add_u32 s56, s56, 1
    s_cmp_lt_u32 s56, 65536
    s_cbranch_scc1 Q1P_7
Q1K_8:
    v_mov_b32 v24, 0xff7fffff
    v_mul_f32 v25, s53, v24
    v_mov_b32 v26, 0
    v_mov_b32 v16, 0
    v_mov_b32 v17, 0
    v_mov_b32 v18, 0
    v_mov_b32 v19, 0
    v_mov_b32 v20, 0
    v_mov_b32 v21, 0
    v_mov_b32 v22, 0
    v_mov_b32 v23, 0
    s_mov_b32 s69, 0
    s_waitcnt vmcnt(36)
    s_add_u32 s44, s52, 4718592
    s_add_u32 s45, s44, 4096
    s_bitcmp1_b32 s66, 9
    s_cselect_b32 s64, 3, 1
    s_swappc_b64 s[70:71], s[72:73]
    s_bitcmp1_b32 s67, 9
    s_cselect_b32 s64, 3, 1
    s_swappc_b64 s[70:71], s[76:77]
    s_add_u32 s44, s52, 5242880
    s_add_u32 s45, s44, 4096
    s_bitcmp1_b32 s66, 10
    s_cselect_b32 s64, 3, 1
    s_waitcnt vmcnt(48)
    s_swappc_b64 s[70:71], s[74:75]
    s_waitcnt vmcnt(48)
    s_bitcmp1_b32 s67, 10
    s_cselect_b32 s64, 3, 1
    s_swappc_b64 s[70:71], s[78:79]
    s_mov_b32 s64, 0
    s_swappc_b64 s[70:71], s[82:83]
    s_lshl_b32 s46, s4, 8
    s_lshl_b32 s57, s3, 6
    s_add_u32 s46, s46, s57
    s_mul_i32 s46, s46, 896
    s_min_u32 s57, s5, 13
    s_lshl_b32 s57, s57, 6
    s_add_u32 s46, s46, s57
    s_lshl_b32 s47, s3, 12
    s_add_u32 s47, s47, 131072
    s_mov_b32 s20, s28
    s_and_b32 s21, s29, 0xffff
    s_mov_b32 s22, 3670016
    s_mov_b32 s23, 0x20000
    v_and_b32 v30, 63, v0
    v_lshrrev_b32 v28, 2, v30
    v_and_b32 v30, 3, v30
    v_lshlrev_b32 v30, 4, v30
    s_mov_b32 s57, 896
    v_mul_lo_u32 v28, v28, s57
    v_add_u32 v30, v30, v28
    s_add_u32 m0, s47, 0
    s_add_u32 s57, s46, 0
    s_waitcnt vmcnt(50)
    buffer_load_dwordx4 v30, s[20:23], s57 offen lds
    s_add_u32 m0, s47, 1024
    s_add_u32 s57, s46, 14336
    buffer_load_dwordx4 v30, s[20:23], s57 offen lds
    s_add_u32 m0, s47, 2048
    s_add_u32 s57, s46, 28672
    buffer_load_dwordx4 v30, s[20:23], s57 offen lds
    s_add_u32 m0, s47, 3072
    s_add_u32 s57, s46, 43008
    buffer_load_dwordx4 v30, s[20:23], s57 offen lds
    s_waitcnt vmcnt(36)
    s_swappc_b64 s[70:71], s[80:81]
    v_and_b32 v30, 63, v0
    s_mov_b32 s57, 3584
    v_mul_lo_u32 v30, v30, s57
    s_lshl_b32 s46, s3, 7
    s_mul_i32 s46, s46, 3584
    s_min_u32 s57, s54, 223
    s_lshl_b32 s57, s57, 4
    s_add_u32 s46, s46, s57
    s_mov_b32 s20, s30
    s_and_b32 s21, s31, 0xffff
    s_mov_b32 s22, 1605632
    s_mov_b32 s23, 0x20000
    s_add_u32 s57, s46, 0
    buffer_load_dwordx4 v[48:51], v30, s[20:23], s57 offen
    s_add_u32 s57, s46, 229376
    buffer_load_dwordx4 v[52:55], v30, s[20:23], s57 offen
    s_mov_b32 s20, s32
    s_and_b32 s21, s33, 0xffff
    s_mov_b32 s22, 1605632
    s_mov_b32 s23, 0x20000
    s_add_u32 s57, s46, 0
    buffer_load_dwordx4 v[56:59], v30, s[20:23], s57 offen
    s_add_u32 s57, s46, 229376
    buffer_load_dwordx4 v[60:63], v30, s[20:23], s57 offen
    s_lshl_b32 s57, s6, 2
    s_and_b32 s58, s7, 3
    s_add_u32 s57, s57, s58
    s_mul_i32 s58, s57, 16
    s_mul_i32 s57, s57, 0
    s_add_u32 s57, s57, 128
    s_cmp_lt_u32 s7, 4
    s_cselect_b32 s101, s58, s57
    s_cselect_b32 s100, 16, 0
    s_add_u32 s100, s100, 68
    s_lshl_b32 s101, s101, 13
    s_add_u32 s101, s101, 14123008
WLOOP:
    s_mov_b64 exec, 1
    v_mov_b32 v30, 163376
    v_mov_b32 v28, 1
    ds_add_rtn_u32 v30, v30, v28
    s_waitcnt lgkmcnt(0)
    v_readfirstlane_b32 s58, v30
    s_mov_b64 exec, -1
    s_nop 2
    s_cmp_ge_u32 s58, s100
    s_cbranch_scc1 WEXIT0
    s_lshr_b32 s57, s58, 2
    s_lshl_b32 s57, s57, 19
    s_and_b32 s59, s58, 3
    s_lshl_b32 s59, s59, 13
    s_add_u32 s57, s57, s59
    s_lshl_b32 s59, s5, 15
    s_add_u32 s57, s57, s59
    s_add_u32 s57, s57, 5767168
    s_lshl_b32 s59, s58, 13
    s_add_u32 s59, s59, s101
    s_cmp_lt_u32 s58, 68
    s_cselect_b32 s44, s57, s59
    s_add_u32 s45, s44, 4096
    s_waitcnt vmcnt(24)
    s_lshr_b32 s57, s44, 19
    s_bitcmp1_b32 s66, s57
    s_cselect_b32 s64, 3, 1
    s_swappc_b64 s[70:71], s[72:73]
    s_waitcnt vmcnt(24)
    s_lshr_b32 s57, s44, 19
    s_bitcmp1_b32 s67, s57
    s_cselect_b32 s64, 3, 1
    s_swappc_b64 s[70:71], s[76:77]
    s_mov_b64 exec, 1
    v_mov_b32 v30, 163376
    v_mov_b32 v28, 1
    ds_add_rtn_u32 v30, v30, v28
    s_waitcnt lgkmcnt(0)
    v_readfirstlane_b32 s58, v30
    s_mov_b64 exec, -1
    s_nop 2
    s_cmp_ge_u32 s58, s100
    s_cbranch_scc1 WEXIT1
    s_lshr_b32 s57, s58, 2
    s_lshl_b32 s57, s57, 19
    s_and_b32 s59, s58, 3
    s_lshl_b32 s59, s59, 13
    s_add_u32 s57, s57, s59
    s_lshl_b32 s59, s5, 15
    s_add_u32 s57, s57, s59
    s_add_u32 s57, s57, 5767168
    s_lshl_b32 s59, s58, 13
    s_add_u32 s59, s59, s101
    s_cmp_lt_u32 s58, 68
    s_cselect_b32 s44, s57, s59
    s_add_u32 s45, s44, 4096
    s_waitcnt vmcnt(24)
    s_lshr_b32 s57, s44, 19
    s_bitcmp1_b32 s66, s57
    s_cselect_b32 s64, 3, 1
    s_swappc_b64 s[70:71], s[74:75]
    s_waitcnt vmcnt(24)
    s_lshr_b32 s57, s44, 19
    s_bitcmp1_b32 s67, s57
    s_cselect_b32 s64, 3, 1
    s_swappc_b64 s[70:71], s[78:79]
    s_branch WLOOP
WEXIT0:
    s_add_u32 s44, s52, 15728640
    s_add_u32 s45, s44, 4096
    s_mov_b32 s64, 1
    s_waitcnt vmcnt(24)
    s_swappc_b64 s[70:71], s[72:73]
    s_waitcnt vmcnt(24)
    s_swappc_b64 s[70:71], s[76:77]
    s_waitcnt vmcnt(24)
    s_add_u32 s44, s52, 16252928
    s_add_u32 s45, s44, 4096
    s_swappc_b64 s[70:71], s[74:75]
    s_waitcnt vmcnt(24)
    s_swappc_b64 s[70:71], s[78:79]
    s_mov_b32 s64, 0
    s_waitcnt vmcnt(24)
    s_swappc_b64 s[70:71], s[72:73]
    s_waitcnt vmcnt(16)
    s_swappc_b64 s[70:71], s[76:77]
    s_waitcnt vmcnt(8)
    s_swappc_b64 s[70:71], s[74:75]
    s_waitcnt vmcnt(0)
    s_swappc_b64 s[70:71], s[78:79]
    s_branch WDONE
WEXIT1:
    s_add_u32 s44, s52, 15728640
    s_add_u32 s45, s44, 4096
    s_mov_b32 s64, 1
    s_waitcnt vmcnt(24)
    s_swappc_b64 s[70:71], s[74:75]
    s_waitcnt vmcnt(24)
    s_swappc_b64 s[70:71], s[78:79]
    s_waitcnt vmcnt(24)
    s_add_u32 s44, s52, 16252928
    s_add_u32 s45, s44, 4096
    s_swappc_b64 s[70:71], s[72:73]
    s_waitcnt vmcnt(24)
    s_swappc_b64 s[70:71], s[76:77]
    s_mov_b32 s64, 0
    s_waitcnt vmcnt(24)
    s_swappc_b64 s[70:71], s[74:75]
    s_waitcnt vmcnt(16)
    s_swappc_b64 s[70:71], s[78:79]
    s_waitcnt vmcnt(8)
    s_swappc_b64 s[70:71], s[72:73]
    s_waitcnt vmcnt(0)
    s_swappc_b64 s[70:71], s[76:77]
WDONE:
    s_swappc_b64 s[70:71], s[84:85]
    v_mov_b32 v24, 0xff7fffff
    v_mul_f32 v25, s53, v24
    v_mov_b32 v26, 0
    v_mov_b32 v16, 0
    v_mov_b32 v17, 0
    v_mov_b32 v18, 0
    v_mov_b32 v19, 0
    v_mov_b32 v20, 0
    v_mov_b32 v21, 0
    v_mov_b32 v22, 0
    v_mov_b32 v23, 0
    s_mov_b32 s69, 1
    s_add_u32 s44, s52, 14155776
    s_add_u32 s45, s44, 4096
    s_mov_b32 s64, 1
    s_swappc_b64 s[70:71], s[74:75]
    s_swappc_b64 s[70:71], s[78:79]
    s_bitcmp1_b32 s66, 1
    s_cselect_b32 s44, s87, s86
    s_add_u32 s44, s44, 3670016
    s_add_u32 s45, s44, 4096
    s_mov_b32 s64, 1
    s_swappc_b64 s[70:71], s[72:73]
    s_bitcmp1_b32 s67, 1
    s_cselect_b32 s44, s87, s86
    s_add_u32 s44, s44, 3670016
    s_add_u32 s45, s44, 4096
    s_swappc_b64 s[70:71], s[76:77]
    s_swappc_b64 s[70:71], s[80:81]
    s_waitcnt vmcnt(24)
    s_bitcmp1_b32 s66, 2
    s_cselect_b32 s44, s87, s86
    s_add_u32 s44, s44, 4194304
    s_add_u32 s45, s44, 4096
    s_mov_b32 s64, 1
    s_swappc_b64 s[70:71], s[74:75]
    s_waitcnt vmcnt(24)
    s_bitcmp1_b32 s67, 2
    s_cselect_b32 s44, s87, s86
    s_add_u32 s44, s44, 4194304
    s_add_u32 s45, s44, 4096
    s_swappc_b64 s[70:71], s[78:79]
    v_bfe_u32 v48, v0, 2, 2
    v_lshlrev_b32 v48, 4, v48
    v_bfe_u32 v30, v0, 4, 2
    v_lshl_add_u32 v48, v30, 2, v48
    s_waitcnt vmcnt(24)
    s_bitcmp1_b32 s66, 1
    s_cselect_b32 s47, s87, s86
    s_add_u32 s47, s47, 3670016
    s_lshr_b32 s47, s47, 7
    s_add_u32 s47, s47, s88
    s_bitcmp1_b32 s66, 2
    s_cselect_b32 s44, s87, s86
    s_add_u32 s44, s44, 4718592
    s_add_u32 s45, s44, 4096
    s_mov_b32 s64, 5
    s_swappc_b64 s[70:71], s[72:73]
    s_waitcnt vmcnt(17)
    s_bitcmp1_b32 s66, 2
    s_cselect_b32 s47, s87, s86
    s_add_u32 s47, s47, 4194304
    s_lshr_b32 s47, s47, 7
    s_add_u32 s47, s47, s88
    s_bitcmp1_b32 s66, 2
    s_cselect_b32 s44, s87, s86
    s_add_u32 s44, s44, 5242880
    s_add_u32 s45, s44, 4096
    s_mov_b32 s64, 5
    s_swappc_b64 s[70:71], s[74:75]
    s_swappc_b64 s[70:71], s[82:83]
    s_bitcmp1_b32 s67, 1
    s_cselect_b32 s46, s87, s86
    s_add_u32 s46, s46, 3670016
    s_lshr_b32 s46, s46, 7
    s_add_u32 s46, s46, s88
    buffer_load_dword v49, v48, s[16:19], s46 offen sc1
    s_bitcmp1_b32 s67, 2
    s_cselect_b32 s46, s87, s86
    s_add_u32 s46, s46, 4194304
    s_lshr_b32 s46, s46, 7
    s_add_u32 s46, s46, s88
    buffer_load_dword v50, v48, s[16:19], s46 offen sc1
    s_waitcnt vmcnt(12)
    s_bitcmp1_b32 s66, 2
    s_cselect_b32 s47, s87, s86
    s_add_u32 s47, s47, 4718592
    s_lshr_b32 s47, s47, 7
    s_add_u32 s47, s47, s88
    s_bitcmp1_b32 s66, 2
    s_cselect_b32 s44, s87, s86
    s_add_u32 s44, s44, 5767168
    s_add_u32 s45, s44, 4096
    s_mov_b32 s64, 5
    s_swappc_b64 s[70:71], s[72:73]
    s_waitcnt vmcnt(12)
    s_bitcmp1_b32 s66, 2
    s_cselect_b32 s47, s87, s86
    s_add_u32 s47, s47, 5242880
    s_lshr_b32 s47, s47, 7
    s_add_u32 s47, s47, s88
    s_bitcmp1_b32 s66, 3
    s_cselect_b32 s44, s87, s86
    s_add_u32 s44, s44, 6291456
    s_add_u32 s45, s44, 4096
    s_mov_b32 s64, 5
    s_swappc_b64 s[70:71], s[74:75]
    s_waitcnt vmcnt(10)
    s_bitcmp1_b32 s66, 2
    s_cselect_b32 s47, s87, s86
    s_add_u32 s47, s47, 5767168
    s_lshr_b32 s47, s47, 7
    s_add_u32 s47, s47, s88
    s_bitcmp1_b32 s66, 3
    s_cselect_b32 s44, s87, s86
    s_add_u32 s44, s44, 6815744
    s_add_u32 s45, s44, 4096
    s_mov_b32 s64, 5
    s_swappc_b64 s[70:71], s[72:73]
    s_bitcmp1_b32 s67, 1
    s_cselect_b32 s65, s87, s86
    s_add_u32 s65, s65, 3670016
    s_lshr_b32 s65, s65, 7
    s_add_u32 s65, s65, s88
    s_bitcmp1_b32 s67, 2
    s_cselect_b32 s44, s87, s86
    s_add_u32 s44, s44, 4718592
    s_add_u32 s45, s44, 4096
    s_lshr_b32 s46, s44, 7
    s_add_u32 s46, s46, s88
    s_mov_b32 s64, 13
    s_swappc_b64 s[70:71], s[76:77]
    s_waitcnt vmcnt(19)
    s_bitcmp1_b32 s66, 3
    s_cselect_b32 s47, s87, s86
    s_add_u32 s47, s47, 6291456
    s_lshr_b32 s47, s47, 7
    s_add_u32 s47, s47, s88
    s_bitcmp1_b32 s66, 3
    s_cselect_b32 s44, s87, s86
    s_add_u32 s44, s44, 7340032
    s_add_u32 s45, s44, 4096
    s_mov_b32 s64, 5
    s_swappc_b64 s[70:71], s[74:75]
    s_bitcmp1_b32 s67, 2
    s_cselect_b32 s65, s87, s86
    s_add_u32 s65, s65, 4194304
    s_lshr_b32 s65, s65, 7
    s_add_u32 s65, s65, s88
    s_bitcmp1_b32 s67, 2
    s_cselect_b32 s44, s87, s86
    s_add_u32 s44, s44, 5242880
    s_add_u32 s45, s44, 4096
    s_lshr_b32 s46, s44, 7
    s_add_u32 s46, s46, s88
    s_mov_b32 s64, 13
    s_swappc_b64 s[70:71], s[78:79]
    s_waitcnt vmcnt(28)
    s_bitcmp1_b32 s66, 3
    s_cselect_b32 s47, s87, s86
    s_add_u32 s47, s47, 6815744
    s_lshr_b32 s47, s47, 7
    s_add_u32 s47, s47, s88
    s_bitcmp1_b32 s66, 3
    s_cselect_b32 s44, s87, s86
    s_add_u32 s44, s44, 7864320
    s_add_u32 s45, s44, 4096
    s_mov_b32 s64, 5
    s_swappc_b64 s[70:71], s[72:73]
    s_waitcnt vmcnt(27)
    s_bitcmp1_b32 s67, 2
    s_cselect_b32 s65, s87, s86
    s_add_u32 s65, s65, 4718592
    s_lshr_b32 s65, s65, 7
    s_add_u32 s65, s65, s88
    s_bitcmp1_b32 s67, 2
    s_cselect_b32 s44, s87, s86
    s_add_u32 s44, s44, 5767168
    s_add_u32 s45, s44, 4096
    s_lshr_b32 s46, s44, 7
    s_add_u32 s46, s46, s88
    s_mov_b32 s64, 13
    s_swappc_b64 s[70:71], s[76:77]
    s_waitcnt vmcnt(28)
    s_bitcmp1_b32 s66, 3
    s_cselect_b32 s47, s87, s86
    s_add_u32 s47, s47, 7340032
    s_lshr_b32 s47, s47, 7
    s_add_u32 s47, s47, s88
    s_bitcmp1_b32 s66, 4
    s_cselect_b32 s44, s87, s86
    s_add_u32 s44, s44, 8388608
    s_add_u32 s45, s44, 4096
    s_mov_b32 s64, 5
    s_swappc_b64 s[70:71], s[74:75]
    s_waitcnt vmcnt(27)
    s_bitcmp1_b32 s67, 2
    s_cselect_b32 s65, s87, s86
    s_add_u32 s65, s65, 5242880
    s_lshr_b32 s65, s65, 7
    s_add_u32 s65, s65, s88
    s_bitcmp1_b32 s67, 3
    s_cselect_b32 s44, s87, s86
    s_add_u32 s44, s44, 6291456
    s_add_u32 s45, s44, 4096
    s_lshr_b32 s46, s44, 7
    s_add_u32 s46, s46, s88
    s_mov_b32 s64, 13
    s_swappc_b64 s[70:71], s[78:79]
    s_waitcnt vmcnt(28)
    s_bitcmp1_b32 s66, 3
    s_cselect_b32 s47, s87, s86
    s_add_u32 s47, s47, 7864320
    s_lshr_b32 s47, s47, 7
    s_add_u32 s47, s47, s88
    s_bitcmp1_b32 s66, 4
    s_cselect_b32 s44, s87, s86
    s_add_u32 s44, s44, 8912896
    s_add_u32 s45, s44, 4096
    s_mov_b32 s64, 5
    s_swappc_b64 s[70:71], s[72:73]
    s_waitcnt vmcnt(27)
    s_bitcmp1_b32 s67, 2
    s_cselect_b32 s65, s87, s86
    s_add_u32 s65, s65, 5767168
    s_lshr_b32 s65, s65, 7
    s_add_u32 s65, s65, s88
    s_bitcmp1_b32 s67, 3
    s_cselect_b32 s44, s87, s86
    s_add_u32 s44, s44, 6815744
    s_add_u32 s45, s44, 4096
    s_lshr_b32 s46, s44, 7
    s_add_u32 s46, s46, s88
    s_mov_b32 s64, 13
    s_swappc_b64 s[70:71], s[76:77]
    s_cmp_ge_u32 s54, 224
    s_cbranch_scc1 WL_9
    s_lshl_b32 s46, s4, 8
    s_lshl_b32 s57, s3, 6
    s_add_u32 s46, s46, s57
    s_mul_i32 s46, s46, 896
    s_min_u32 s57, s5, 13
    s_lshl_b32 s57, s57, 6
    s_add_u32 s46, s46, s57
    s_add_u32 s47, s55, 0
    s_mov_b32 s20, s28
    s_and_b32 s21, s29, 0xffff
    s_mov_b32 s22, 3670016
    s_mov_b32 s23, 0x20000
    v_and_b32 v30, 63, v0
    v_lshrrev_b32 v28, 2, v30
    v_and_b32 v30, 3, v30
    v_lshlrev_b32 v30, 4, v30
    s_mov_b32 s57, 896
    v_mul_lo_u32 v28, v28, s57
    v_add_u32 v30, v30, v28
    s_add_u32 m0, s47, 0
    s_add_u32 s57, s46, 0
    buffer_load_dwordx4 v30, s[20:23], s57 offen lds
    s_add_u32 m0, s47, 1024
    s_add_u32 s57, s46, 14336
    buffer_load_dwordx4 v30, s[20:23], s57 offen lds
    s_add_u32 m0, s47, 2048
    s_add_u32 s57, s46, 28672
    buffer_load_dwordx4 v30, s[20:23], s57 offen lds
    s_add_u32 m0, s47, 3072
    s_add_u32 s57, s46, 43008
    buffer_load_dwordx4 v30, s[20:23], s57 offen lds
WL_9:
    s_waitcnt vmcnt(28)
    s_bitcmp1_b32 s66, 4
    s_cselect_b32 s47, s87, s86
    s_add_u32 s47, s47, 8388608
    s_lshr_b32 s47, s47, 7
    s_add_u32 s47, s47, s88
    s_bitcmp1_b32 s66, 4
    s_cselect_b32 s44, s87, s86
    s_add_u32 s44, s44, 9437184
    s_add_u32 s45, s44, 4096
    s_mov_b32 s64, 5
    s_swappc_b64 s[70:71], s[74:75]
    s_waitcnt vmcnt(27)
    s_bitcmp1_b32 s67, 3
    s_cselect_b32 s65, s87, s86
    s_add_u32 s65, s65, 6291456
    s_lshr_b32 s65, s65, 7
    s_add_u32 s65, s65, s88
    s_bitcmp1_b32 s67, 3
    s_cselect_b32 s44, s87, s86
    s_add_u32 s44, s44, 7340032
    s_add_u32 s45, s44, 4096
    s_lshr_b32 s46, s44, 7
    s_add_u32 s46, s46, s88
    s_mov_b32 s64, 13
    s_swappc_b64 s[70:71], s[78:79]
    s_waitcnt vmcnt(28)
    s_bitcmp1_b32 s66, 4
    s_cselect_b32 s47, s87, s86
    s_add_u32 s47, s47, 8912896
    s_lshr_b32 s47, s47, 7
    s_add_u32 s47, s47, s88
    s_bitcmp1_b32 s66, 4
    s_cselect_b32 s44, s87, s86
    s_add_u32 s44, s44, 9961472
    s_add_u32 s45, s44, 4096
    s_mov_b32 s64, 5
    s_swappc_b64 s[70:71], s[72:73]
    s_waitcnt vmcnt(27)
    s_bitcmp1_b32 s67, 3
    s_cselect_b32 s65, s87, s86
    s_add_u32 s65, s65, 6815744
    s_lshr_b32 s65, s65, 7
    s_add_u32 s65, s65, s88
    s_bitcmp1_b32 s67, 3
    s_cselect_b32 s44, s87, s86
    s_add_u32 s44, s44, 7864320
    s_add_u32 s45, s44, 4096
    s_lshr_b32 s46, s44, 7
    s_add_u32 s46, s46, s88
    s_mov_b32 s64, 13
    s_swappc_b64 s[70:71], s[76:77]
    s_waitcnt vmcnt(28)
    s_bitcmp1_b32 s66, 4
    s_cselect_b32 s47, s87, s86
    s_add_u32 s47, s47, 9437184
    s_lshr_b32 s47, s47, 7
    s_add_u32 s47, s47, s88
    s_bitcmp1_b32 s66, 5
    s_cselect_b32 s44, s87, s86
    s_add_u32 s44, s44, 10485760
    s_add_u32 s45, s44, 4096
    s_mov_b32 s64, 5
    s_swappc_b64 s[70:71], s[74:75]
    s_waitcnt vmcnt(27)
    s_bitcmp1_b32 s67, 3
    s_cselect_b32 s65, s87, s86
    s_add_u32 s65, s65, 7340032
    s_lshr_b32 s65, s65, 7
    s_add_u32 s65, s65, s88
    s_bitcmp1_b32 s67, 4
    s_cselect_b32 s44, s87, s86
    s_add_u32 s44, s44, 8388608
    s_add_u32 s45, s44, 4096
    s_lshr_b32 s46, s44, 7
    s_add_u32 s46, s46, s88
    s_mov_b32 s64, 13
    s_swappc_b64 s[70:71], s[78:79]
    s_waitcnt vmcnt(28)
    s_bitcmp1_b32 s66, 4
    s_cselect_b32 s47, s87, s86
    s_add_u32 s47, s47, 9961472
    s_lshr_b32 s47, s47, 7
    s_add_u32 s47, s47, s88
    s_bitcmp1_b32 s66, 5
    s_cselect_b32 s44, s87, s86
    s_add_u32 s44, s44, 11010048
    s_add_u32 s45, s44, 4096
    s_mov_b32 s64, 5
    s_swappc_b64 s[70:71], s[72:73]
    s_waitcnt vmcnt(27)
    s_bitcmp1_b32 s67, 3
    s_cselect_b32 s65, s87, s86
    s_add_u32 s65, s65, 7864320
    s_lshr_b32 s65, s65, 7
    s_add_u32 s65, s65, s88
    s_bitcmp1_b32 s67, 4
    s_cselect_b32 s44, s87, s86
    s_add_u32 s44, s44, 8912896
    s_add_u32 s45, s44, 4096
    s_lshr_b32 s46, s44, 7
    s_add_u32 s46, s46, s88
    s_mov_b32 s64, 13
    s_swappc_b64 s[70:71], s[76:77]
    s_waitcnt vmcnt(28)
    s_bitcmp1_b32 s66, 5
    s_cselect_b32 s47, s87, s86
    s_add_u32 s47, s47, 10485760
    s_lshr_b32 s47, s47, 7
    s_add_u32 s47, s47, s88
    s_bitcmp1_b32 s66, 5
    s_cselect_b32 s44, s87, s86
    s_add_u32 s44, s44, 11534336
    s_add_u32 s45, s44, 4096
    s_mov_b32 s64, 5
    s_swappc_b64 s[70:71], s[74:75]
    s_waitcnt vmcnt(27)
    s_bitcmp1_b32 s67, 4
    s_cselect_b32 s65, s87, s86
    s_add_u32 s65, s65, 8388608
    s_lshr_b32 s65, s65, 7
    s_add_u32 s65, s65, s88
    s_bitcmp1_b32 s67, 4
    s_cselect_b32 s44, s87, s86
    s_add_u32 s44, s44, 9437184
    s_add_u32 s45, s44, 4096
    s_lshr_b32 s46, s44, 7
    s_add_u32 s46, s46, s88
    s_mov_b32 s64, 13
    s_swappc_b64 s[70:71], s[78:79]
    s_waitcnt vmcnt(28)
    s_bitcmp1_b32 s66, 5
    s_cselect_b32 s47, s87, s86
    s_add_u32 s47, s47, 11010048
    s_lshr_b32 s47, s47, 7
    s_add_u32 s47, s47, s88
    s_bitcmp1_b32 s66, 5
    s_cselect_b32 s44, s87, s86
    s_add_u32 s44, s44, 12058624
    s_add_u32 s45, s44, 4096
    s_mov_b32 s64, 5
    s_swappc_b64 s[70:71], s[72:73]
    s_waitcnt vmcnt(27)
    s_bitcmp1_b32 s67, 4
    s_cselect_b32 s65, s87, s86
    s_add_u32 s65, s65, 8912896
    s_lshr_b32 s65, s65, 7
    s_add_u32 s65, s65, s88
    s_bitcmp1_b32 s67, 4
    s_cselect_b32 s44, s87, s86
    s_add_u32 s44, s44, 9961472
    s_add_u32 s45, s44, 4096
    s_lshr_b32 s46, s44, 7
    s_add_u32 s46, s46, s88
    s_mov_b32 s64, 13
    s_swappc_b64 s[70:71], s[76:77]
    s_waitcnt vmcnt(28)
    s_bitcmp1_b32 s66, 5
    s_cselect_b32 s47, s87, s86
    s_add_u32 s47, s47, 11534336
    s_lshr_b32 s47, s47, 7
    s_add_u32 s47, s47, s88
    s_bitcmp1_b32 s66, 6
    s_cselect_b32 s44, s87, s86
    s_add_u32 s44, s44, 12582912
    s_add_u32 s45, s44, 4096
    s_mov_b32 s64, 5
    s_swappc_b64 s[70:71], s[74:75]
    s_waitcnt vmcnt(27)
    s_bitcmp1_b32 s67, 4
    s_cselect_b32 s65, s87, s86
    s_add_u32 s65, s65, 9437184
    s_lshr_b32 s65, s65, 7
    s_add_u32 s65, s65, s88
    s_bitcmp1_b32 s67, 5
    s_cselect_b32 s44, s87, s86
    s_add_u32 s44, s44, 10485760
    s_add_u32 s45, s44, 4096
    s_lshr_b32 s46, s44, 7
    s_add_u32 s46, s46, s88
    s_mov_b32 s64, 13
    s_swappc_b64 s[70:71], s[78:79]
    s_waitcnt vmcnt(28)
    s_bitcmp1_b32 s66, 5
    s_cselect_b32 s47, s87, s86
    s_add_u32 s47, s47, 12058624
    s_lshr_b32 s47, s47, 7
    s_add_u32 s47, s47, s88
    s_bitcmp1_b32 s66, 6
    s_cselect_b32 s44, s87, s86
    s_add_u32 s44, s44, 13107200
    s_add_u32 s45, s44, 4096
    s_mov_b32 s64, 5
    s_swappc_b64 s[70:71], s[72:73]
    s_waitcnt vmcnt(27)
    s_bitcmp1_b32 s67, 4
    s_cselect_b32 s65, s87, s86
    s_add_u32 s65, s65, 9961472
    s_lshr_b32 s65, s65, 7
    s_add_u32 s65, s65, s88
    s_bitcmp1_b32 s67, 5
    s_cselect_b32 s44, s87, s86
    s_add_u32 s44, s44, 11010048
    s_add_u32 s45, s44, 4096
    s_lshr_b32 s46, s44, 7
    s_add_u32 s46, s46, s88
    s_mov_b32 s64, 13
    s_swappc_b64 s[70:71], s[76:77]
    s_waitcnt vmcnt(28)
    s_bitcmp1_b32 s66, 6
    s_cselect_b32 s47, s87, s86
    s_add_u32 s47, s47, 12582912
    s_lshr_b32 s47, s47, 7
    s_add_u32 s47, s47, s88
    s_bitcmp1_b32 s66, 6
    s_cselect_b32 s44, s87, s86
    s_add_u32 s44, s44, 13631488
    s_add_u32 s45, s44, 4096
    s_mov_b32 s64, 5
    s_swappc_b64 s[70:71], s[74:75]
    s_waitcnt vmcnt(27)
    s_bitcmp1_b32 s67, 5
    s_cselect_b32 s65, s87, s86
    s_add_u32 s65, s65, 10485760
    s_lshr_b32 s65, s65, 7
    s_add_u32 s65, s65, s88
    s_bitcmp1_b32 s67, 5
    s_cselect_b32 s44, s87, s86
    s_add_u32 s44, s44, 11534336
    s_add_u32 s45, s44, 4096
    s_lshr_b32 s46, s44, 7
    s_add_u32 s46, s46, s88
    s_mov_b32 s64, 13
    s_swappc_b64 s[70:71], s[78:79]
    s_waitcnt vmcnt(28)
    s_bitcmp1_b32 s66, 6
    s_cselect_b32 s47, s87, s86
    s_add_u32 s47, s47, 13107200
    s_lshr_b32 s47, s47, 7
    s_add_u32 s47, s47, s88
    s_bitcmp1_b32 s66, 7
    s_cselect_b32 s44, s87, s86
    s_add_u32 s44, s44, 14680064
    s_add_u32 s45, s44, 4096
    s_mov_b32 s64, 5
    s_swappc_b64 s[70:71], s[72:73]
    s_waitcnt vmcnt(27)
    s_bitcmp1_b32 s67, 5
    s_cselect_b32 s65, s87, s86
    s_add_u32 s65, s65, 11010048
    s_lshr_b32 s65, s65, 7
    s_add_u32 s65, s65, s88
    s_bitcmp1_b32 s67, 5
    s_cselect_b32 s44, s87, s86
    s_add_u32 s44, s44, 12058624
    s_add_u32 s45, s44, 4096
    s_lshr_b32 s46, s44, 7
    s_add_u32 s46, s46, s88
    s_mov_b32 s64, 13
    s_swappc_b64 s[70:71], s[76:77]
    s_waitcnt vmcnt(28)
    s_bitcmp1_b32 s66, 6
    s_cselect_b32 s47, s87, s86
    s_add_u32 s47, s47, 13631488
    s_lshr_b32 s47, s47, 7
    s_add_u32 s47, s47, s88
    s_bitcmp1_b32 s66, 7
    s_cselect_b32 s44, s87, s86
    s_add_u32 s44, s44, 15204352
    s_add_u32 s45, s44, 4096
    s_mov_b32 s64, 5
    s_swappc_b64 s[70:71], s[74:75]
    s_waitcnt vmcnt(27)
    s_bitcmp1_b32 s67, 5
    s_cselect_b32 s65, s87, s86
    s_add_u32 s65, s65, 11534336
    s_lshr_b32 s65, s65, 7
    s_add_u32 s65, s65, s88
    s_bitcmp1_b32 s67, 6
    s_cselect_b32 s44, s87, s86
    s_add_u32 s44, s44, 12582912
    s_add_u32 s45, s44, 4096
    s_lshr_b32 s46, s44, 7
    s_add_u32 s46, s46, s88
    s_mov_b32 s64, 13
    s_swappc_b64 s[70:71], s[78:79]
    s_waitcnt vmcnt(28)
    s_bitcmp1_b32 s66, 7
    s_cselect_b32 s47, s87, s86
    s_add_u32 s47, s47, 14680064
    s_lshr_b32 s47, s47, 7
    s_add_u32 s47, s47, s88
    s_mov_b32 s64, 4
    s_swappc_b64 s[70:71], s[72:73]
    s_waitcnt vmcnt(19)
    s_bitcmp1_b32 s67, 5
    s_cselect_b32 s65, s87, s86
    s_add_u32 s65, s65, 12058624
    s_lshr_b32 s65, s65, 7
    s_add_u32 s65, s65, s88
    s_bitcmp1_b32 s67, 6
    s_cselect_b32 s44, s87, s86
    s_add_u32 s44, s44, 13107200
    s_add_u32 s45, s44, 4096
    s_lshr_b32 s46, s44, 7
    s_add_u32 s46, s46, s88
    s_mov_b32 s64, 13
    s_swappc_b64 s[70:71], s[76:77]
    s_waitcnt vmcnt(20)
    s_bitcmp1_b32 s66, 7
    s_cselect_b32 s47, s87, s86
    s_add_u32 s47, s47, 15204352
    s_lshr_b32 s47, s47, 7
    s_add_u32 s47, s47, s88
    s_mov_b32 s64, 4
    s_swappc_b64 s[70:71], s[74:75]
    s_waitcnt vmcnt(11)
    s_bitcmp1_b32 s67, 6
    s_cselect_b32 s65, s87, s86
    s_add_u32 s65, s65, 12582912
    s_lshr_b32 s65, s65, 7
    s_add_u32 s65, s65, s88
    s_bitcmp1_b32 s67, 6
    s_cselect_b32 s44, s87, s86
    s_add_u32 s44, s44, 13631488
    s_add_u32 s45, s44, 4096
    s_lshr_b32 s46, s44, 7
    s_add_u32 s46, s46, s88
    s_mov_b32 s64, 13
    s_swappc_b64 s[70:71], s[78:79]
    s_waitcnt vmcnt(10)
    s_bitcmp1_b32 s67, 6
    s_cselect_b32 s65, s87, s86
    s_add_u32 s65, s65, 13107200
    s_lshr_b32 s65, s65, 7
    s_add_u32 s65, s65, s88
    s_bitcmp1_b32 s67, 7
    s_cselect_b32 s44, s87, s86
    s_add_u32 s44, s44, 14680064
    s_add_u32 s45, s44, 4096
    s_lshr_b32 s46, s44, 7
    s_add_u32 s46, s46, s88
    s_mov_b32 s64, 13
    s_swappc_b64 s[70:71], s[76:77]
    s_waitcnt vmcnt(9)
    s_bitcmp1_b32 s67, 6
    s_cselect_b32 s65, s87, s86
    s_add_u32 s65, s65, 13631488
    s_lshr_b32 s65, s65, 7
    s_add_u32 s65, s65, s88
    s_bitcmp1_b32 s67, 7
    s_cselect_b32 s44, s87, s86
    s_add_u32 s44, s44, 15204352
    s_add_u32 s45, s44, 4096
    s_lshr_b32 s46, s44, 7
    s_add_u32 s46, s46, s88
    s_mov_b32 s64, 13
    s_swappc_b64 s[70:71], s[78:79]
    s_waitcnt vmcnt(9)
    s_bitcmp1_b32 s67, 7
    s_cselect_b32 s65, s87, s86
    s_add_u32 s65, s65, 14680064
    s_lshr_b32 s65, s65, 7
    s_add_u32 s65, s65, s88
    s_mov_b32 s64, 8
    s_swappc_b64 s[70:71], s[76:77]
    s_cmp_ge_u32 s54, 224
    s_cbranch_scc1 WL_10
    s_lshl_b32 s46, s3, 7
    s_mul_i32 s46, s46, 3584
    s_min_u32 s57, s54, 223
    s_lshl_b32 s57, s57, 4
    s_add_u32 s46, s46, s57
    s_add_u32 s47, s55, 4096
    s_mov_b32 s20, s30
    s_and_b32 s21, s31, 0xffff
    s_mov_b32 s22, 1605632
    s_mov_b32 s23, 0x20000
    v_and_b32 v30, 63, v0
    s_mov_b32 s57, 3584
    v_mul_lo_u32 v30, v30, s57
    s_add_u32 m0, s47, 0
    s_add_u32 s57, s46, 0
    buffer_load_dwordx4 v30, s[20:23], s57 offen lds
    s_cmp_eq_u32 s3, 3
    s_cbranch_scc1 DS_11
    s_add_u32 m0, s47, 1024
    s_add_u32 s57, s46, 229376
    buffer_load_dwordx4 v30, s[20:23], s57 offen lds
DS_11:
    s_lshl_b32 s46, s3, 7
    s_mul_i32 s46, s46, 3584
    s_min_u32 s57, s54, 223
    s_lshl_b32 s57, s57, 4
    s_add_u32 s46, s46, s57
    s_add_u32 s47, s55, 4096
    s_cmp_eq_u32 s3, 3
    s_cselect_b32 s57, 1, 2
    s_lshl_b32 s57, s57, 10
    s_add_u32 s47, s47, s57
    s_mov_b32 s20, s32
    s_and_b32 s21, s33, 0xffff
    s_mov_b32 s22, 1605632
    s_mov_b32 s23, 0x20000
    v_and_b32 v30, 63, v0
    s_mov_b32 s57, 3584
    v_mul_lo_u32 v30, v30, s57
    s_add_u32 m0, s47, 0
    s_add_u32 s57, s46, 0
    buffer_load_dwordx4 v30, s[20:23], s57 offen lds
    s_cmp_eq_u32 s3, 3
    s_cbranch_scc1 DS_12
    s_add_u32 m0, s47, 1024
    s_add_u32 s57, s46, 229376
    buffer_load_dwordx4 v30, s[20:23], s57 offen lds
DS_12:
WL_10:
    s_waitcnt vmcnt(0)
    s_bitcmp1_b32 s67, 7
    s_cselect_b32 s65, s87, s86
    s_add_u32 s65, s65, 15204352
    s_lshr_b32 s65, s65, 7
    s_add_u32 s65, s65, s88
    s_mov_b32 s64, 8
    s_swappc_b64 s[70:71], s[78:79]
    s_cmp_ge_u32 s54, 56
    s_cbranch_scc1 WL_13
    s_mul_i32 s46, s3, 401408
    s_min_u32 s57, s54, 55
    s_lshl_b32 s57, s57, 4
    s_add_u32 s46, s46, s57
    s_add_u32 s47, s55, 8192
    s_mov_b32 s20, s34
    s_and_b32 s21, s35, 0xffff
    s_mov_b32 s22, 1605632
    s_mov_b32 s23, 0x20000
    v_and_b32 v30, 63, v0
    s_mov_b32 s57, 896
    v_mul_lo_u32 v30, v30, s57
    s_add_u32 m0, s47, 0
    s_add_u32 s57, s46, 0
    buffer_load_dwordx4 v30, s[20:23], s57 offen lds
    s_add_u32 m0, s47, 1024
    s_add_u32 s57, s46, 57344
    buffer_load_dwordx4 v30, s[20:23], s57 offen lds
    s_add_u32 m0, s47, 2048
    s_add_u32 s57, s46, 114688
    buffer_load_dwordx4 v30, s[20:23], s57 offen lds
    s_add_u32 m0, s47, 3072
    s_add_u32 s57, s46, 172032
    buffer_load_dwordx4 v30, s[20:23], s57 offen lds
    s_add_u32 m0, s47, 4096
    s_add_u32 s57, s46, 229376
    buffer_load_dwordx4 v30, s[20:23], s57 offen lds
    s_add_u32 m0, s47, 5120
    s_add_u32 s57, s46, 286720
    buffer_load_dwordx4 v30, s[20:23], s57 offen lds
    s_add_u32 m0, s47, 6144
    s_add_u32 s57, s46, 344064
    buffer_load_dwordx4 v30, s[20:23], s57 offen lds
WL_13:
    s_swappc_b64 s[70:71], s[84:85]
    s_endpgm
MID:
    s_nop 1
    v_add_f32_dpp v26, v26, v26 row_ror:4 row_mask:0xf bank_mask:0xf
    s_nop 1
    v_add_f32_dpp v26, v26, v26 row_ror:8 row_mask:0xf bank_mask:0xf
    s_nop 1
    v_readlane_b32 s40, v26, 0
    v_readlane_b32 s41, v26, 16
    v_readlane_b32 s42, v26, 32
    v_readlane_b32 s43, v26, 48
    s_nop 1
    v_mov_b32 v26, s40
    v_add_f32 v26, s41, v26
    v_add_f32 v26, s42, v26
    v_add_f32 v26, s43, v26
    v_and_b32 v30, 63, v0
    v_and_b32 v32, 15, v30
    v_lshrrev_b32 v33, 4, v30
    v_lshlrev_b32 v32, 5, v32
    v_lshl_add_u32 v32, v33, 4, v32
    s_mul_i32 s57, s3, 1040
    s_add_u32 s57, s57, 147456
    v_add_u32 v32, s57, v32
    v_mov_b32 v33, s57
    v_mov_b32 v34, v24
    v_mov_b32 v35, v26
    ds_write_b64 v33, v[34:35] offset:1024
    v_cmp_gt_u32 vcc, 32, v30
    s_and_saveexec_b64 s[60:61], vcc
    ds_write_b128 v32, v[16:19]
    ds_write_b128 v32, v[20:23] offset:512
    s_mov_b64 exec, s[60:61]
    v_lshlrev_b32 v32, 2, v0
    v_mov_b32 v33, 147456
    v_add_u32 v34, 147456, v32
    s_lshl_b32 s57, s4, 4
    s_add_u32 s57, s57, s5
    s_mul_i32 s57, s57, 1152
    s_mul_i32 s63, s69, 294912
    s_add_u32 s63, s63, 0
    s_add_u32 s57, s57, s63
    s_waitcnt lgkmcnt(0)
    s_barrier
    ds_read_b64 v[40:41], v33 offset:1024
    ds_read_b64 v[42:43], v33 offset:2064
    ds_read_b64 v[44:45], v33 offset:3104
    ds_read_b64 v[46:47], v33 offset:4144
    ds_read_b32 v36, v34 offset:0
    ds_read_b32 v37, v34 offset:1040
    ds_read_b32 v38, v34 offset:2080
    ds_read_b32 v39, v34 offset:3120
    s_waitcnt lgkmcnt(4)
    v_max_f32 v34, v40, v42
    v_max3_f32 v34, v44, v46, v34
    v_sub_f32 v40, v40, v34
    v_sub_f32 v42, v42, v34
    v_sub_f32 v44, v44, v34
    v_sub_f32 v46, v46, v34
    v_mul_f32 v40, s53, v40
    v_mul_f32 v42, s53, v42
    v_mul_f32 v44, s53, v44
    v_mul_f32 v46, s53, v46
    v_exp_f32 v40, v40
    v_exp_f32 v42, v42
    v_exp_f32 v44, v44
    v_exp_f32 v46, v46
    s_waitcnt lgkmcnt(0)
    v_mul_f32 v36, v36, v40
    v_mul_f32 v35, v41, v40
    v_fmac_f32 v36, v37, v42
    v_fmac_f32 v35, v43, v42
    v_fmac_f32 v36, v38, v44
    v_fmac_f32 v35, v45, v44
    v_fmac_f32 v36, v39, v46
    v_fmac_f32 v35, v47, v46
    buffer_store_dword v36, v32, s[16:19], s57 offen sc1
    v_cmp_eq_u32 vcc, 0, v0
    s_and_saveexec_b64 s[60:61], vcc
    s_cbranch_execz PZ_14
    v_mov_b32 v32, 1024
    buffer_store_dwordx2 v[34:35], v32, s[16:19], s57 offen sc1
PZ_14:
    s_mov_b64 exec, s[60:61]
    s_cmp_ge_u32 s5, 14
    s_cbranch_scc1 S2X_15
    s_lshl_b32 s47, s3, 12
    s_add_u32 s47, s47, 131072
    s_add_u32 s63, s55, 0
    s_cmp_eq_u32 s69, 0
    s_cselect_b32 s47, s47, s63
    v_and_b32 v30, 63, v0
    v_lshrrev_b32 v28, 4, v30
    v_bfe_u32 v26, v30, 2, 2
    v_lshl_add_u32 v26, v28, 3, v26
    v_mul_u32_u24 v26, 64, v26
    v_and_b32 v28, 3, v30
    v_lshl_add_u32 v26, v28, 3, v26
    v_add_u32 v26, s47, v26
    ds_read_b64_tr_b16 v[8:9], v26 offset:0
    ds_read_b64_tr_b16 v[10:11], v26 offset:256
    ds_read_b64_tr_b16 v[12:13], v26 offset:32
    ds_read_b64_tr_b16 v[14:15], v26 offset:288
    ds_read_b64_tr_b16 v[16:17], v26 offset:2048
    ds_read_b64_tr_b16 v[18:19], v26 offset:2304
    ds_read_b64_tr_b16 v[20:21], v26 offset:2080
    ds_read_b64_tr_b16 v[22:23], v26 offset:2336
    s_mul_i32 s57, s4, 18432
    s_mul_i32 s46, s69, 294912
    s_add_u32 s46, s46, 0
    s_add_u32 s46, s46, s57
    v_lshlrev_b32 v26, 2, v0
    v_and_b32 v30, 15, v0
    v_mul_u32_u24 v28, 1152, v30
    v_add_u32 v28, 1024, v28
    s_mov_b32 s56, 0
PL_17:
    buffer_load_dwordx2 v[24:25], v28, s[16:19], s46 offen sc1
    s_waitcnt vmcnt(0)
    v_max_u32 v30, v24, v25
    v_cmp_eq_u32 vcc, -1, v30
    s_nop 1
    s_and_b32 s57, vcc_lo, 0xffff
    s_bcnt1_i32_b32 s57, s57
    s_cmp_le_u32 s57, 4
    s_cbranch_scc1 PD_18
    s_add_u32 s56, s56, 1
    s_cmp_lt_u32 s56, 65536
    s_sleep 3
    s_cbranch_scc1 PL_17
PD_18:
    s_mov_b32 s56, 0
PL_19:
    s_add_u32 s57, s46, 0
    buffer_load_dword v32, v26, s[16:19], s57 offen sc1
    s_add_u32 s57, s46, 1152
    buffer_load_dword v33, v26, s[16:19], s57 offen sc1
    s_add_u32 s57, s46, 2304
    buffer_load_dword v34, v26, s[16:19], s57 offen sc1
    s_add_u32 s57, s46, 3456
    buffer_load_dword v35, v26, s[16:19], s57 offen sc1
    s_add_u32 s57, s46, 4608
    buffer_load_dword v36, v26, s[16:19], s57 offen sc1
    s_add_u32 s57, s46, 5760
    buffer_load_dword v37, v26, s[16:19], s57 offen sc1
    s_add_u32 s57, s46, 6912
    buffer_load_dword v38, v26, s[16:19], s57 offen sc1
    s_add_u32 s57, s46, 8064
    buffer_load_dword v39, v26, s[16:19], s57 offen sc1
    s_add_u32 s57, s46, 9216
    buffer_load_dword v40, v26, s[16:19], s57 offen sc1
    s_add_u32 s57, s46, 10368
    buffer_load_dword v41, v26, s[16:19], s57 offen sc1
    s_add_u32 s57, s46, 11520
    buffer_load_dword v42, v26, s[16:19], s57 offen sc1
    s_add_u32 s57, s46, 12672
    buffer_load_dword v43, v26, s[16:19], s57 offen sc1
    s_add_u32 s57, s46, 13824
    buffer_load_dword v44, v26, s[16:19], s57 offen sc1
    s_add_u32 s57, s46, 14976
    buffer_load_dword v45, v26, s[16:19], s57 offen sc1
    s_add_u32 s57, s46, 16128
    buffer_load_dword v46, v26, s[16:19], s57 offen sc1
    s_add_u32 s57, s46, 17280
    buffer_load_dword v47, v26, s[16:19], s57 offen sc1
    buffer_load_dwordx2 v[24:25], v28, s[16:19], s46 offen sc1
    s_waitcnt vmcnt(0)
    v_max_u32 v30, v32, v33
    v_max3_u32 v30, v34, v35, v30
    v_max3_u32 v30, v36, v37, v30
    v_max3_u32 v30, v38, v39, v30
    v_max3_u32 v30, v40, v41, v30
    v_max3_u32 v30, v42, v43, v30
    v_max3_u32 v30, v44, v45, v30
    v_max3_u32 v30, v46, v47, v30
    v_max3_u32 v30, v24, v25, v30
    v_cmp_eq_u32 vcc, -1, v30
    s_cbranch_vccz PD_20
    s_add_u32 s56, s56, 1
    s_cmp_lt_u32 s56, 65536
    s_sleep 2
    s_cbranch_scc1 PL_19
PD_20:
    s_waitcnt lgkmcnt(0)
    s_cmp_lg_u32 s69, 0
    s_cbranch_scc1 P0_21
    s_min_u32 s58, s54, 223
    s_and_b32 s46, s58, 3
    s_mul_i32 s46, s46, 448
    s_lshl_b32 s57, s3, 7
    s_add_u32 s46, s46, s57
    s_mul_i32 s46, s46, 896
    s_lshr_b32 s57, s58, 2
    s_lshl_b32 s57, s57, 4
    s_add_u32 s46, s46, s57
    s_lshl_b32 s47, s3, 12
    s_add_u32 s47, s47, 131072
    s_mov_b32 s20, s34
    s_and_b32 s21, s35, 0xffff
    s_mov_b32 s22, 1605632
    s_mov_b32 s23, 0x20000
    v_and_b32 v30, 63, v0
    s_mov_b32 s57, 896
    v_mul_lo_u32 v30, v30, s57
    s_add_u32 m0, s47, 0
    s_add_u32 s57, s46, 0
    buffer_load_dwordx4 v30, s[20:23], s57 offen lds
    s_cmp_eq_u32 s3, 3
    s_cbranch_scc1 DS_22
    s_add_u32 m0, s47, 1024
    s_add_u32 s57, s46, 57344
    buffer_load_dwordx4 v30, s[20:23], s57 offen lds
DS_22:
P0_21:
    v_mov_b32 v26, v24
    s_nop 1
    v_max_f32_dpp v26, v26, v26 quad_perm:[1,0,3,2] row_mask:0xf bank_mask:0xf
    s_nop 1
    v_max_f32_dpp v26, v26, v26 quad_perm:[2,3,0,1] row_mask:0xf bank_mask:0xf
    s_nop 1
    v_max_f32_dpp v26, v26, v26 row_half_mirror row_mask:0xf bank_mask:0xf
    s_nop 1
    v_max_f32_dpp v26, v26, v26 row_mirror row_mask:0xf bank_mask:0xf
    v_sub_f32 v24, v24, v26
    v_mul_f32 v24, s53, v24
    v_exp_f32 v24, v24
    v_lshlrev_b32 v27, 1, v0
    v_mul_f32 v25, v25, v24
    s_nop 1
    v_add_f32_dpp v25, v25, v25 quad_perm:[1,0,3,2] row_mask:0xf bank_mask:0xf
    s_nop 1
    v_add_f32_dpp v25, v25, v25 quad_perm:[2,3,0,1] row_mask:0xf bank_mask:0xf
    s_nop 1
    v_add_f32_dpp v25, v25, v25 row_half_mirror row_mask:0xf bank_mask:0xf
    s_nop 1
    v_add_f32_dpp v25, v25, v25 row_mirror row_mask:0xf bank_mask:0xf
    v_rcp_f32 v25, v25
    v_add_u32 v27, 161792, v27
    v_mul_f32_dpp v26, v24, v32 row_newbcast:0 row_mask:0xf bank_mask:0xf
    v_mul_f32_dpp v28, v24, v33 row_newbcast:1 row_mask:0xf bank_mask:0xf
    v_mul_f32_dpp v29, v24, v34 row_newbcast:2 row_mask:0xf bank_mask:0xf
    v_fmac_f32_dpp v26, v24, v35 row_newbcast:3 row_mask:0xf bank_mask:0xf
    v_fmac_f32_dpp v28, v24, v36 row_newbcast:4 row_mask:0xf bank_mask:0xf
    v_fmac_f32_dpp v29, v24, v37 row_newbcast:5 row_mask:0xf bank_mask:0xf
    v_fmac_f32_dpp v26, v24, v38 row_newbcast:6 row_mask:0xf bank_mask:0xf
    v_fmac_f32_dpp v28, v24, v39 row_newbcast:7 row_mask:0xf bank_mask:0xf
    v_fmac_f32_dpp v29, v24, v40 row_newbcast:8 row_mask:0xf bank_mask:0xf
    v_fmac_f32_dpp v26, v24, v41 row_newbcast:9 row_mask:0xf bank_mask:0xf
    v_fmac_f32_dpp v28, v24, v42 row_newbcast:10 row_mask:0xf bank_mask:0xf
    v_fmac_f32_dpp v29, v24, v43 row_newbcast:11 row_mask:0xf bank_mask:0xf
    v_fmac_f32_dpp v26, v24, v44 row_newbcast:12 row_mask:0xf bank_mask:0xf
    v_fmac_f32_dpp v28, v24, v45 row_newbcast:13 row_mask:0xf bank_mask:0xf
    v_fmac_f32_dpp v29, v24, v46 row_newbcast:14 row_mask:0xf bank_mask:0xf
    v_fmac_f32_dpp v26, v24, v47 row_newbcast:15 row_mask:0xf bank_mask:0xf
    v_add_f32 v26, v26, v28
    v_add_f32 v26, v26, v29
    v_mul_f32 v26, v26, v25
    v_cvt_pk_bf16_f32 v26, v26, v26
    ds_write_b16 v27, v26
    v_bfe_u32 v28, v0, 4, 2
    v_lshlrev_b32 v28, 4, v28
    s_lshl_b32 s57, s3, 7
    s_add_u32 s57, s57, 161792
    v_add_u32 v28, s57, v28
    v_and_b32 v29, 15, v0
    v_lshlrev_b32 v29, 3, v29
    s_lshl_b32 s57, s3, 7
    s_add_u32 s57, s57, 162816
    v_add_u32 v29, s57, v29
    s_waitcnt lgkmcnt(0)
    ds_read_b128 v[32:35], v28
    ds_read_b128 v[36:39], v28 offset:64
    s_waitcnt lgkmcnt(1)
    v_mfma_f32_16x16x32_bf16 v[40:43], v[32:35], v[8:11], 0
    v_mfma_f32_16x16x32_bf16 v[44:47], v[32:35], v[12:15], 0
    s_waitcnt lgkmcnt(0)
    v_mfma_f32_16x16x32_bf16 v[40:43], v[36:39], v[16:19], v[40:43]
    v_mfma_f32_16x16x32_bf16 v[44:47], v[36:39], v[20:23], v[44:47]
    s_nop 7
    v_mov_b32 v41, v44
    s_mov_b64 exec, 0xffff
    ds_write_b64 v29, v[40:41]
    s_mov_b64 exec, -1
    s_waitcnt lgkmcnt(0)
    s_barrier
    s_cmp_lg_u32 s3, 0
    s_cbranch_scc1 S2D_16
    v_and_b32 v30, 15, v0
    v_lshlrev_b32 v30, 3, v30
    v_add_u32 v30, 162816, v30
    ds_read_b64 v[32:33], v30 offset:0
    ds_read_b64 v[34:35], v30 offset:128
    ds_read_b64 v[36:37], v30 offset:256
    ds_read_b64 v[38:39], v30 offset:384
    s_waitcnt lgkmcnt(0)
    v_add_f32 v32, v32, v34
    v_add_f32 v36, v36, v38
    v_add_f32 v33, v33, v35
    v_add_f32 v37, v37, v39
    v_add_f32 v32, v32, v36
    v_add_f32 v33, v33, v37
    v_cmp_gt_u32 vcc, 16, v0
    s_mul_i32 s57, s4, 1792
    s_lshl_b32 s58, s5, 7
    s_add_u32 s57, s57, s58
    v_cndmask_b32 v32, v33, v32, vcc
    s_mul_i32 s58, s69, 28672
    s_add_u32 s58, s58, 589824
    s_add_u32 s57, s57, s58
    v_lshlrev_b32 v34, 2, v0
    s_mov_b32 exec_hi, 0
    buffer_store_dword v32, v34, s[16:19], s57 offen sc1
    s_mov_b64 exec, -1
    s_branch S2D_16
S2X_15:
    s_waitcnt vmcnt(0)
    s_cmp_lg_u32 s69, 0
    s_cbranch_scc1 P0_23
    s_min_u32 s58, s54, 223
    s_and_b32 s46, s58, 3
    s_mul_i32 s46, s46, 448
    s_lshl_b32 s57, s3, 7
    s_add_u32 s46, s46, s57
    s_mul_i32 s46, s46, 896
    s_lshr_b32 s57, s58, 2
    s_lshl_b32 s57, s57, 4
    s_add_u32 s46, s46, s57
    s_lshl_b32 s47, s3, 12
    s_add_u32 s47, s47, 131072
    s_mov_b32 s20, s34
    s_and_b32 s21, s35, 0xffff
    s_mov_b32 s22, 1605632
    s_mov_b32 s23, 0x20000
    v_and_b32 v30, 63, v0
    s_mov_b32 s57, 896
    v_mul_lo_u32 v30, v30, s57
    s_add_u32 m0, s47, 0
    s_add_u32 s57, s46, 0
    buffer_load_dwordx4 v30, s[20:23], s57 offen lds
    s_cmp_eq_u32 s3, 3
    s_cbranch_scc1 DS_24
    s_add_u32 m0, s47, 1024
    s_add_u32 s57, s46, 57344
    buffer_load_dwordx4 v30, s[20:23], s57 offen lds
DS_24:
P0_23:
    s_barrier
S2D_16:
    s_cmp_lg_u32 s69, 0
    s_cbranch_scc0 MW_25
    s_cmp_ge_u32 s54, 224
    s_cbranch_scc1 FIN
MW_25:
    s_cmp_lg_u32 s69, 0
    s_cbranch_scc1 P0_26
    s_lshl_b32 s47, s3, 12
    s_add_u32 s47, s47, 147456
    v_and_b32 v30, 63, v0
    v_lshlrev_b32 v30, 4, v30
    v_add_u32 v30, s47, v30
    s_cmp_eq_u32 s3, 3
    s_cbranch_scc1 W3_27
    ds_write_b128 v30, v[48:51] offset:0
    ds_write_b128 v30, v[52:55] offset:1024
    ds_write_b128 v30, v[56:59] offset:2048
    ds_write_b128 v30, v[60:63] offset:3072
    s_branch W4_28
W3_27:
    ds_write_b128 v30, v[48:51]
    ds_write_b128 v30, v[56:59] offset:1024
W4_28:
    s_waitcnt lgkmcnt(0)
P0_26:
    s_lshl_b32 s47, s3, 12
    s_add_u32 s47, s47, 147456
    s_add_u32 s63, s55, 4096
    s_cmp_eq_u32 s69, 0
    s_cselect_b32 s47, s47, s63
    v_and_b32 v30, 63, v0
    v_lshrrev_b32 v28, 4, v30
    v_bfe_u32 v27, v30, 2, 2
    v_lshl_add_u32 v27, v28, 3, v27
    v_mul_u32_u24 v27, 16, v27
    v_and_b32 v28, 1, v30
    v_lshl_add_u32 v27, v28, 3, v27
    s_cmp_eq_u32 s3, 3
    s_cselect_b32 s57, 1, 2
    s_lshl_b32 s57, s57, 10
    v_bfe_u32 v28, v30, 1, 1
    v_mul_lo_u32 v28, v28, s57
    v_add_u32 v27, v27, v28
    v_add_u32 v27, s47, v27
    ds_read_b64_tr_b16 v[8:9], v27 offset:0
    ds_read_b64_tr_b16 v[10:11], v27 offset:64
    ds_read_b64_tr_b16 v[12:13], v27 offset:512
    ds_read_b64_tr_b16 v[14:15], v27 offset:576
    ds_read_b64_tr_b16 v[16:17], v27 offset:1024
    ds_read_b64_tr_b16 v[18:19], v27 offset:1088
    ds_read_b64_tr_b16 v[20:21], v27 offset:1536
    ds_read_b64_tr_b16 v[22:23], v27 offset:1600
    v_lshlrev_b32 v26, 2, v0
    v_add_u32 v26, 161792, v26
    v_bfe_u32 v27, v0, 4, 2
    v_lshlrev_b32 v27, 4, v27
    s_lshl_b32 s57, s3, 8
    s_add_u32 s57, s57, 161792
    v_add_u32 v27, s57, v27
    v_and_b32 v28, 15, v0
    v_lshlrev_b32 v28, 3, v28
    s_lshl_b32 s57, s3, 7
    s_add_u32 s57, s57, 162816
    v_add_u32 v28, s57, v28
    v_and_b32 v30, 15, v0
    v_cmp_eq_u32 s[62:63], 1, v30
    v_mov_b32 v29, 0x3f803f80
    s_mul_i32 s46, s69, 28672
    s_add_u32 s46, s46, 589824
    v_min_u32 v25, 223, v0
    v_lshlrev_b32 v25, 3, v25
    v_and_b32 v24, 15, v0
    v_mul_u32_u24 v24, 1792, v24
    s_min_u32 s57, s5, 13
    s_lshl_b32 s57, s57, 7
    s_add_u32 s47, s46, s57
    s_sleep 10
    s_mov_b32 s56, 0
PL_29:
    buffer_load_dword v32, v24, s[16:19], s47 offen offset:124 sc1
    s_waitcnt vmcnt(0)
    v_mov_b32 v30, v32
    v_cmp_eq_u32 vcc, -1, v30
    s_cbranch_vccz PD_30
    s_add_u32 s56, s56, 1
    s_cmp_lt_u32 s56, 65536
    s_sleep 1
    s_cbranch_scc1 PL_29
PD_30:
    s_sleep 2
    s_mov_b32 s56, 0
PL_31:
    s_add_u32 s57, s46, 0
    buffer_load_dwordx2 v[32:33], v25, s[16:19], s57 offen sc1
    s_add_u32 s57, s46, 1792
    buffer_load_dwordx2 v[34:35], v25, s[16:19], s57 offen sc1
    s_add_u32 s57, s46, 3584
    buffer_load_dwordx2 v[36:37], v25, s[16:19], s57 offen sc1
    s_add_u32 s57, s46, 5376
    buffer_load_dwordx2 v[38:39], v25, s[16:19], s57 offen sc1
    s_add_u32 s57, s46, 7168
    buffer_load_dwordx2 v[40:41], v25, s[16:19], s57 offen sc1
    s_add_u32 s57, s46, 8960
    buffer_load_dwordx2 v[42:43], v25, s[16:19], s57 offen sc1
    s_add_u32 s57, s46, 10752
    buffer_load_dwordx2 v[44:45], v25, s[16:19], s57 offen sc1
    s_add_u32 s57, s46, 12544
    buffer_load_dwordx2 v[46:47], v25, s[16:19], s57 offen sc1
    s_add_u32 s57, s46, 14336
    buffer_load_dwordx2 v[48:49], v25, s[16:19], s57 offen sc1
    s_add_u32 s57, s46, 16128
    buffer_load_dwordx2 v[50:51], v25, s[16:19], s57 offen sc1
    s_add_u32 s57, s46, 17920
    buffer_load_dwordx2 v[52:53], v25, s[16:19], s57 offen sc1
    s_add_u32 s57, s46, 19712
    buffer_load_dwordx2 v[54:55], v25, s[16:19], s57 offen sc1
    s_add_u32 s57, s46, 21504
    buffer_load_dwordx2 v[56:57], v25, s[16:19], s57 offen sc1
    s_add_u32 s57, s46, 23296
    buffer_load_dwordx2 v[58:59], v25, s[16:19], s57 offen sc1
    s_add_u32 s57, s46, 25088
    buffer_load_dwordx2 v[60:61], v25, s[16:19], s57 offen sc1
    s_add_u32 s57, s46, 26880
    buffer_load_dwordx2 v[62:63], v25, s[16:19], s57 offen sc1
    s_waitcnt vmcnt(0)
    v_max_u32 v30, v32, v33
    v_max3_u32 v30, v34, v35, v30
    v_max3_u32 v30, v36, v37, v30
    v_max3_u32 v30, v38, v39, v30
    v_max3_u32 v30, v40, v41, v30
    v_max3_u32 v30, v42, v43, v30
    v_max3_u32 v30, v44, v45, v30
    v_max3_u32 v30, v46, v47, v30
    v_max3_u32 v30, v48, v49, v30
    v_max3_u32 v30, v50, v51, v30
    v_max3_u32 v30, v52, v53, v30
    v_max3_u32 v30, v54, v55, v30
    v_max3_u32 v30, v56, v57, v30
    v_max3_u32 v30, v58, v59, v30
    v_max3_u32 v30, v60, v61, v30
    v_max3_u32 v30, v62, v63, v30
    v_cmp_eq_u32 vcc, -1, v30
    s_cbranch_vccz PD_32
    s_add_u32 s56, s56, 1
    s_cmp_lt_u32 s56, 65536
    s_sleep 2
    s_cbranch_scc1 PL_31
PD_32:
    s_waitcnt lgkmcnt(0)
    s_cmp_lg_u32 s69, 0
    s_cbranch_scc1 P0_33
    s_lshl_b32 s46, s3, 7
    s_mul_i32 s46, s46, 8192
    s_lshl_b32 s57, s4, 9
    s_add_u32 s46, s46, s57
    s_lshl_b32 s57, s5, 5
    s_add_u32 s46, s46, s57
    s_lshl_b32 s47, s3, 12
    s_add_u32 s47, s47, 147456
    s_mov_b32 s20, s26
    s_and_b32 s21, s27, 0xffff
    s_mov_b32 s22, 3670016
    s_mov_b32 s23, 0x20000
    v_and_b32 v30, 63, v0
    v_lshrrev_b32 v25, 1, v30
    v_and_b32 v30, 1, v30
    v_lshlrev_b32 v30, 4, v30
    s_mov_b32 s57, 8192
    v_mul_lo_u32 v25, v25, s57
    v_add_u32 v30, v30, v25
    s_add_u32 m0, s47, 0
    s_add_u32 s57, s46, 0
    buffer_load_dwordx4 v30, s[20:23], s57 offen lds
    s_add_u32 m0, s47, 1024
    s_add_u32 s57, s46, 262144
    buffer_load_dwordx4 v30, s[20:23], s57 offen lds
    s_cmp_eq_u32 s3, 3
    s_cbranch_scc1 DS_34
    s_add_u32 m0, s47, 2048
    s_add_u32 s57, s46, 524288
    buffer_load_dwordx4 v30, s[20:23], s57 offen lds
    s_add_u32 m0, s47, 3072
    s_add_u32 s57, s46, 786432
    buffer_load_dwordx4 v30, s[20:23], s57 offen lds
DS_34:
P0_33:
    v_add_f32 v32, v32, v48
    v_add_f32 v33, v33, v49
    v_add_f32 v34, v34, v50
    v_add_f32 v35, v35, v51
    v_add_f32 v36, v36, v52
    v_add_f32 v37, v37, v53
    v_add_f32 v38, v38, v54
    v_add_f32 v39, v39, v55
    v_add_f32 v40, v40, v56
    v_add_f32 v41, v41, v57
    v_add_f32 v42, v42, v58
    v_add_f32 v43, v43, v59
    v_add_f32 v44, v44, v60
    v_add_f32 v45, v45, v61
    v_add_f32 v46, v46, v62
    v_add_f32 v47, v47, v63
    v_add_f32 v32, v32, v40
    v_add_f32 v33, v33, v41
    v_add_f32 v34, v34, v42
    v_add_f32 v35, v35, v43
    v_add_f32 v36, v36, v44
    v_add_f32 v37, v37, v45
    v_add_f32 v38, v38, v46
    v_add_f32 v39, v39, v47
    v_add_f32 v32, v32, v36
    v_add_f32 v33, v33, v37
    v_add_f32 v34, v34, v38
    v_add_f32 v35, v35, v39
    v_add_f32 v32, v32, v34
    v_add_f32 v33, v33, v35
    v_cvt_pk_bf16_f32 v32, v32, v33
    v_lshlrev_b32 v34, 16, v31
    v_and_b32 v35, 0xffff0000, v31
    v_and_b32 v33, 0xffff0000, v32
    v_lshlrev_b32 v32, 16, v32
    v_cmp_gt_u32 vcc, 224, v0
    v_add_f32 v34, v34, v32
    v_add_f32 v35, v35, v33
    v_cvt_pk_bf16_f32 v31, v34, v35
    v_cndmask_b32 v31, 0, v31, vcc
    ds_write_b32 v26, v31
    s_cmp_lt_u32 s54, 224
    s_cbranch_scc1 S3R_36
    s_sleep 4
    s_cmp_eq_u32 s5, 14
    s_cselect_b32 s20, s8, s12
    s_cselect_b32 s21, s9, s13
    s_mov_b32 s22, 16777216
    s_mov_b32 s23, 0x20000
    s_lshl_b32 s46, s3, 1
    s_add_u32 s46, s46, 1
    s_cmp_eq_u32 s5, 14
    s_cselect_b32 s57, s66, s67
    s_lshl_b32 s58, s46, 2
    s_lshr_b32 s57, s57, s58
    s_and_b32 s57, s57, 15
    s_or_b32 s57, s57, 16
    s_ff1_i32_b32 s57, s57
    s_and_b32 s57, s57, 3
    s_lshl_b32 s57, s57, 19
    s_lshl_b32 s47, s46, 21
    s_add_u32 s47, s47, s57
    s_add_u32 s47, s47, 327680
    v_mov_b32 v32, 66560
    buffer_load_dword v33, v32, s[20:23], s47 offen nt
    v_mov_b32 v32, 74752
    buffer_load_dword v34, v32, s[20:23], s47 offen nt
    s_waitcnt vmcnt(0) lgkmcnt(0)
    s_mov_b32 s60, -1
    s_mov_b32 s61, -1
    v_mov_b32 v32, 4096
    s_memtime s[58:59]
    s_waitcnt lgkmcnt(0)
    buffer_load_dword v33, v32, s[20:23], s47 offen nt
    s_waitcnt vmcnt(0)
    s_memtime s[62:63]
    s_waitcnt lgkmcnt(0)
    s_sub_u32 s57, s62, s58
    s_min_u32 s60, s60, s57
    v_mov_b32 v32, 12288
    s_memtime s[58:59]
    s_waitcnt lgkmcnt(0)
    buffer_load_dword v33, v32, s[20:23], s47 offen nt
    s_waitcnt vmcnt(0)
    s_memtime s[62:63]
    s_waitcnt lgkmcnt(0)
    s_sub_u32 s57, s62, s58
    s_min_u32 s61, s61, s57
    s_cmp_gt_u32 s61, s60
    s_cselect_b32 s57, 0, 1
    s_xor_b32 s57, s57, s6
    s_add_u32 s57, s57, 1
    v_mov_b32 v33, s57
    s_sub_u32 s57, s5, 14
    s_lshl_b32 s57, s57, 3
    s_add_u32 s57, s57, s46
    s_sub_u32 s57, s57, 1
    s_lshl_b32 s57, s57, 2
    s_lshl_b32 s58, s4, 6
    s_add_u32 s57, s57, s58
    s_add_u32 s57, s57, 677888
    v_and_b32 v32, 1, v0
    v_lshlrev_b32 v32, 2, v32
    s_mov_b64 exec, 3
    buffer_store_dword v33, v32, s[16:19], s57 offen sc1
    s_mov_b64 exec, -1
    s_branch S3X_35
S3R_36:
    s_waitcnt lgkmcnt(0)
    ds_read_b128 v[40:43], v27 offset:0
    ds_read_b128 v[44:47], v27 offset:64
    ds_read_b128 v[48:51], v27 offset:128
    ds_read_b128 v[52:55], v27 offset:192
    v_mov_b32 v32, 0
    v_mov_b32 v33, 0
    v_mov_b32 v34, 0
    v_mov_b32 v35, 0
    v_mov_b32 v36, 0
    v_mov_b32 v37, 0
    v_mov_b32 v38, 0
    v_mov_b32 v39, 0
    s_waitcnt lgkmcnt(3)
    v_cndmask_b32 v56, v40, v29, s[62:63]
    v_cndmask_b32 v57, v41, v29, s[62:63]
    v_cndmask_b32 v58, v42, v29, s[62:63]
    v_cndmask_b32 v59, v43, v29, s[62:63]
    s_nop 1
    v_mfma_f32_16x16x32_bf16 v[32:35], v[56:59], v[8:11], v[32:35]
    v_mfma_f32_16x16x32_bf16 v[36:39], v[56:59], v[40:43], v[36:39]
    s_waitcnt lgkmcnt(2)
    v_cndmask_b32 v60, v44, v29, s[62:63]
    v_cndmask_b32 v61, v45, v29, s[62:63]
    v_cndmask_b32 v62, v46, v29, s[62:63]
    v_cndmask_b32 v63, v47, v29, s[62:63]
    s_nop 1
    v_mfma_f32_16x16x32_bf16 v[32:35], v[60:63], v[12:15], v[32:35]
    v_mfma_f32_16x16x32_bf16 v[36:39], v[60:63], v[44:47], v[36:39]
    s_cmp_eq_u32 s3, 3
    s_cbranch_scc1 GK_37
    s_waitcnt lgkmcnt(1)
    v_cndmask_b32 v56, v48, v29, s[62:63]
    v_cndmask_b32 v57, v49, v29, s[62:63]
    v_cndmask_b32 v58, v50, v29, s[62:63]
    v_cndmask_b32 v59, v51, v29, s[62:63]
    s_nop 1
    v_mfma_f32_16x16x32_bf16 v[32:35], v[56:59], v[16:19], v[32:35]
    v_mfma_f32_16x16x32_bf16 v[36:39], v[56:59], v[48:51], v[36:39]
    s_waitcnt lgkmcnt(0)
    v_cndmask_b32 v60, v52, v29, s[62:63]
    v_cndmask_b32 v61, v53, v29, s[62:63]
    v_cndmask_b32 v62, v54, v29, s[62:63]
    v_cndmask_b32 v63, v55, v29, s[62:63]
    s_nop 1
    v_mfma_f32_16x16x32_bf16 v[32:35], v[60:63], v[20:23], v[32:35]
    v_mfma_f32_16x16x32_bf16 v[36:39], v[60:63], v[52:55], v[36:39]
GK_37:
    s_waitcnt lgkmcnt(0)
    s_lshl_b32 s57, s3, 3
    s_add_u32 s57, s57, 163328
    v_mov_b32 v30, s57
    s_nop 5
    s_mov_b64 exec, 0xffff
    ds_write_b64 v28, v[32:33]
    ds_write_b64 v30, v[36:37]
    s_mov_b64 exec, -1
    s_waitcnt lgkmcnt(0)
    s_barrier
    s_cmp_lg_u32 s3, 0
    s_cbranch_scc1 S3X_35
    v_and_b32 v30, 15, v0
    v_lshlrev_b32 v30, 3, v30
    v_add_u32 v30, 162816, v30
    v_mov_b32 v48, 163328
    ds_read_b128 v[40:43], v48
    ds_read_b128 v[44:47], v48 offset:16
    ds_read_b64 v[32:33], v30 offset:0
    ds_read_b64 v[34:35], v30 offset:128
    ds_read_b64 v[36:37], v30 offset:256
    ds_read_b64 v[38:39], v30 offset:384
    s_waitcnt lgkmcnt(4)
    v_add_f32 v40, v40, v42
    v_add_f32 v44, v44, v46
    v_add_f32 v41, v41, v43
    v_add_f32 v45, v45, v47
    v_add_f32 v42, v40, v44
    v_add_f32 v40, v41, v45
    v_mul_f32 v40, 0x3b124925, v40
    v_mul_f32 v41, 0x3b124925, v42
    v_fma_f32 v41, -v40, v40, v41
    v_max_f32 v41, 0, v41
    v_add_f32 v41, 0x3727c5ac, v41
    v_rsq_f32 v41, v41
    s_waitcnt lgkmcnt(0)
    v_add_f32 v32, v32, v34
    v_add_f32 v36, v36, v38
    v_add_f32 v33, v33, v35
    v_add_f32 v37, v37, v39
    v_add_f32 v32, v32, v36
    v_add_f32 v33, v33, v37
    v_fma_f32 v32, -v40, v33, v32
    v_mul_f32 v32, v32, v41
    v_cvt_pk_bf16_f32 v32, v32, v32
    v_and_b32 v32, 0xffff0000, v32
    v_mul_f32 v34, 0xbfb8aa3b, v32
    v_exp_f32 v34, v34
    v_mov_b32_dpp v33, v32 row_ror:8 row_mask:0xf bank_mask:0xf
    v_add_f32 v34, 1.0, v34
    v_rcp_f32 v34, v34
    s_lshl_b32 s57, s54, 4
    v_mul_f32 v34, v34, v32
    v_cvt_pk_bf16_f32 v34, v34, v34
    v_and_b32 v34, 0xffff0000, v34
    v_mul_f32 v34, v34, v33
    s_mul_i32 s58, s69, 3584
    s_add_u32 s58, s58, 647168
    s_add_u32 s57, s57, s58
    v_mov_b32_dpp v35, v34 quad_perm:[1,0,3,2] row_mask:0xf bank_mask:0xf
    v_lshlrev_b32 v36, 1, v0
    v_cvt_pk_bf16_f32 v34, v34, v35
    s_mov_b64 exec, 0x55
    buffer_store_dword v34, v36, s[16:19], s57 offen sc1
    s_mov_b64 exec, -1
S3X_35:
    s_cmp_lg_u32 s69, 0
    s_cbranch_scc1 TAIL4
    s_cmp_lt_u32 s54, 224
    s_cbranch_scc1 S4G_39
    s_waitcnt vmcnt(0)
    s_branch S4X_38
S4G_39:
    s_lshl_b32 s47, s3, 12
    s_add_u32 s47, s47, 131072
    v_and_b32 v30, 63, v0
    v_lshrrev_b32 v28, 4, v30
    v_bfe_u32 v27, v30, 2, 2
    v_lshl_add_u32 v27, v28, 3, v27
    v_mul_u32_u24 v27, 16, v27
    v_and_b32 v28, 1, v30
    v_lshl_add_u32 v27, v28, 3, v27
    v_add_u32 v27, s47, v27
    ds_read_b64_tr_b16 v[8:9], v27 offset:0
    ds_read_b64_tr_b16 v[10:11], v27 offset:64
    ds_read_b64_tr_b16 v[12:13], v27 offset:512
    ds_read_b64_tr_b16 v[14:15], v27 offset:576
    ds_read_b64_tr_b16 v[16:17], v27 offset:1024
    ds_read_b64_tr_b16 v[18:19], v27 offset:1088
    ds_read_b64_tr_b16 v[20:21], v27 offset:1536
    ds_read_b64_tr_b16 v[22:23], v27 offset:1600
    v_bfe_u32 v25, v0, 4, 2
    v_lshlrev_b32 v25, 4, v25
    v_and_b32 v28, 15, v0
    v_lshlrev_b32 v28, 3, v28
    s_lshl_b32 s57, s3, 7
    s_add_u32 s57, s57, 162816
    v_add_u32 v28, s57, v28
    s_and_b32 s46, s54, 3
    s_mul_i32 s46, s46, 896
    s_lshl_b32 s57, s3, 8
    s_add_u32 s46, s46, s57
    s_cmp_eq_u32 s3, 3
    s_cselect_b32 s47, 0, 128
    s_add_u32 s46, s46, 647168
    s_sleep 16
    s_mov_b32 s56, 0
PL_40:
    buffer_load_dwordx4 v[48:51], v25, s[16:19], s46 offen offset:0 sc1
    buffer_load_dwordx4 v[52:55], v25, s[16:19], s46 offen offset:64 sc1
    s_add_u32 s57, s46, s47
    buffer_load_dwordx4 v[56:59], v25, s[16:19], s57 offen offset:0 sc1
    s_add_u32 s57, s46, s47
    buffer_load_dwordx4 v[60:63], v25, s[16:19], s57 offen offset:64 sc1
    s_waitcnt vmcnt(0)
    v_max_u32 v30, v48, v49
    v_max3_u32 v30, v50, v51, v30
    v_max3_u32 v30, v52, v53, v30
    v_max3_u32 v30, v54, v55, v30
    v_max3_u32 v30, v56, v57, v30
    v_max3_u32 v30, v58, v59, v30
    v_max3_u32 v30, v60, v61, v30
    v_max3_u32 v30, v62, v63, v30
    v_cmp_eq_u32 vcc, -1, v30
    s_cbranch_vccz PD_41
    s_add_u32 s56, s56, 1
    s_cmp_lt_u32 s56, 65536
    s_sleep 2
    s_cbranch_scc1 PL_40
PD_41:
    s_waitcnt lgkmcnt(0)
    v_mfma_f32_16x16x32_bf16 v[32:35], v[48:51], v[8:11], 0
    v_mfma_f32_16x16x32_bf16 v[36:39], v[52:55], v[12:15], 0
    s_cmp_eq_u32 s3, 3
    s_cbranch_scc1 GK_42
    v_mfma_f32_16x16x32_bf16 v[32:35], v[56:59], v[16:19], v[32:35]
    v_mfma_f32_16x16x32_bf16 v[36:39], v[60:63], v[20:23], v[36:39]
GK_42:
    s_nop 7
    v_add_f32 v32, v32, v36
    s_mov_b64 exec, 0xffff
    ds_write_b64 v28, v[32:33]
    s_mov_b64 exec, -1
    s_waitcnt lgkmcnt(0)
    s_barrier
    s_cmp_lg_u32 s3, 0
    s_cbranch_scc1 S4X_38
    v_and_b32 v30, 15, v0
    v_lshlrev_b32 v30, 3, v30
    v_add_u32 v30, 162816, v30
    ds_read_b64 v[32:33], v30 offset:0
    ds_read_b64 v[34:35], v30 offset:128
    ds_read_b64 v[36:37], v30 offset:256
    ds_read_b64 v[38:39], v30 offset:384
    s_waitcnt lgkmcnt(0)
    v_add_f32 v32, v32, v34
    v_add_f32 v36, v36, v38
    v_add_f32 v33, v33, v35
    v_add_f32 v37, v37, v39
    v_add_f32 v32, v32, v36
    v_add_f32 v33, v33, v37
    s_and_b32 s57, s54, 3
    s_mul_i32 s57, s57, 1792
    s_lshr_b32 s58, s54, 2
    s_lshl_b32 s58, s58, 5
    s_add_u32 s57, s57, s58
    s_add_u32 s57, s57, 654336
    v_lshlrev_b32 v34, 2, v0
    s_mov_b64 exec, 0xff
    buffer_store_dword v32, v34, s[16:19], s57 offen sc1
    s_mov_b64 exec, -1
S4X_38:
    s_lshl_b32 s47, s3, 12
    s_add_u32 s47, s47, 147456
    v_and_b32 v30, 63, v0
    v_lshrrev_b32 v28, 4, v30
    v_bfe_u32 v27, v30, 2, 2
    v_lshl_add_u32 v27, v28, 3, v27
    v_mul_u32_u24 v27, 32, v27
    v_and_b32 v28, 3, v30
    v_lshl_add_u32 v27, v28, 3, v27
    v_add_u32 v27, s47, v27
    ds_read_b64_tr_b16 v[8:9], v27 offset:0
    ds_read_b64_tr_b16 v[10:11], v27 offset:128
    ds_read_b64_tr_b16 v[12:13], v27 offset:1024
    ds_read_b64_tr_b16 v[14:15], v27 offset:1152
    ds_read_b64_tr_b16 v[16:17], v27 offset:2048
    ds_read_b64_tr_b16 v[18:19], v27 offset:2176
    ds_read_b64_tr_b16 v[20:21], v27 offset:3072
    ds_read_b64_tr_b16 v[22:23], v27 offset:3200
    v_lshlrev_b32 v26, 2, v0
    v_add_u32 v26, 161792, v26
    v_bfe_u32 v27, v0, 4, 2
    v_lshlrev_b32 v27, 4, v27
    s_lshl_b32 s57, s3, 8
    s_add_u32 s57, s57, 161792
    v_add_u32 v27, s57, v27
    v_and_b32 v28, 15, v0
    v_lshlrev_b32 v28, 3, v28
    s_lshl_b32 s57, s3, 7
    s_add_u32 s57, s57, 162816
    v_add_u32 v28, s57, v28
    v_and_b32 v30, 15, v0
    v_cmp_eq_u32 s[62:63], 1, v30
    v_mov_b32 v29, 0x3f803f80
    v_min_u32 v25, 223, v0
    v_lshlrev_b32 v25, 3, v25
    s_sleep 15
    s_mov_b32 s56, 0
PL_43:
    s_mov_b32 s57, 654336
    buffer_load_dwordx2 v[32:33], v25, s[16:19], s57 offen sc1
    s_mov_b32 s57, 656128
    buffer_load_dwordx2 v[34:35], v25, s[16:19], s57 offen sc1
    s_mov_b32 s57, 657920
    buffer_load_dwordx2 v[36:37], v25, s[16:19], s57 offen sc1
    s_mov_b32 s57, 659712
    buffer_load_dwordx2 v[38:39], v25, s[16:19], s57 offen sc1
    s_waitcnt vmcnt(0)
    v_max_u32 v30, v32, v33
    v_max3_u32 v30, v34, v35, v30
    v_max3_u32 v30, v36, v37, v30
    v_max3_u32 v30, v38, v39, v30
    v_cmp_eq_u32 vcc, -1, v30
    s_cbranch_vccz PD_44
    s_add_u32 s56, s56, 1
    s_cmp_lt_u32 s56, 65536
    s_sleep 2
    s_cbranch_scc1 PL_43
PD_44:
    v_add_f32 v32, v32, v34
    v_add_f32 v33, v33, v35
    v_add_f32 v36, v36, v38
    v_add_f32 v37, v37, v39
    v_add_f32 v32, v32, v36
    v_add_f32 v33, v33, v37
    v_cvt_pk_bf16_f32 v32, v32, v33
    v_lshlrev_b32 v34, 16, v31
    v_and_b32 v35, 0xffff0000, v31
    v_and_b32 v33, 0xffff0000, v32
    v_lshlrev_b32 v32, 16, v32
    v_cmp_gt_u32 vcc, 224, v0
    v_add_f32 v34, v34, v32
    v_add_f32 v35, v35, v33
    v_cvt_pk_bf16_f32 v31, v34, v35
    v_cndmask_b32 v31, 0, v31, vcc
    ds_write_b32 v26, v31
    s_waitcnt lgkmcnt(0)
    ds_read_b128 v[40:43], v27 offset:0
    ds_read_b128 v[44:47], v27 offset:64
    ds_read_b128 v[48:51], v27 offset:128
    ds_read_b128 v[52:55], v27 offset:192
    v_mov_b32 v32, 0
    v_mov_b32 v33, 0
    v_mov_b32 v34, 0
    v_mov_b32 v35, 0
    v_mov_b32 v36, 0
    v_mov_b32 v37, 0
    v_mov_b32 v38, 0
    v_mov_b32 v39, 0
    s_waitcnt lgkmcnt(3)
    v_cndmask_b32 v56, v40, v29, s[62:63]
    v_cndmask_b32 v57, v41, v29, s[62:63]
    v_cndmask_b32 v58, v42, v29, s[62:63]
    v_cndmask_b32 v59, v43, v29, s[62:63]
    s_nop 1
    v_mfma_f32_16x16x32_bf16 v[32:35], v[56:59], v[8:11], v[32:35]
    v_mfma_f32_16x16x32_bf16 v[36:39], v[56:59], v[40:43], v[36:39]
    s_waitcnt lgkmcnt(2)
    v_cndmask_b32 v60, v44, v29, s[62:63]
    v_cndmask_b32 v61, v45, v29, s[62:63]
    v_cndmask_b32 v62, v46, v29, s[62:63]
    v_cndmask_b32 v63, v47, v29, s[62:63]
    s_nop 1
    v_mfma_f32_16x16x32_bf16 v[32:35], v[60:63], v[12:15], v[32:35]
    v_mfma_f32_16x16x32_bf16 v[36:39], v[60:63], v[44:47], v[36:39]
    s_cmp_eq_u32 s3, 3
    s_cbranch_scc1 GK_45
    s_waitcnt lgkmcnt(1)
    v_cndmask_b32 v56, v48, v29, s[62:63]
    v_cndmask_b32 v57, v49, v29, s[62:63]
    v_cndmask_b32 v58, v50, v29, s[62:63]
    v_cndmask_b32 v59, v51, v29, s[62:63]
    s_nop 1
    v_mfma_f32_16x16x32_bf16 v[32:35], v[56:59], v[16:19], v[32:35]
    v_mfma_f32_16x16x32_bf16 v[36:39], v[56:59], v[48:51], v[36:39]
    s_waitcnt lgkmcnt(0)
    v_cndmask_b32 v60, v52, v29, s[62:63]
    v_cndmask_b32 v61, v53, v29, s[62:63]
    v_cndmask_b32 v62, v54, v29, s[62:63]
    v_cndmask_b32 v63, v55, v29, s[62:63]
    s_nop 1
    v_mfma_f32_16x16x32_bf16 v[32:35], v[60:63], v[20:23], v[32:35]
    v_mfma_f32_16x16x32_bf16 v[36:39], v[60:63], v[52:55], v[36:39]
GK_45:
    s_waitcnt lgkmcnt(0)
    s_lshl_b32 s57, s3, 3
    s_add_u32 s57, s57, 163328
    v_mov_b32 v30, s57
    s_nop 5
    s_mov_b64 exec, 0xffff
    ds_write_b64 v28, v[32:33]
    ds_write_b64 v30, v[36:37]
    s_mov_b64 exec, -1
    s_waitcnt lgkmcnt(0)
    s_barrier
    s_cmp_lg_u32 s3, 0
    s_cbranch_scc1 S5X_46
    v_and_b32 v30, 15, v0
    v_lshlrev_b32 v30, 3, v30
    v_add_u32 v30, 162816, v30
    v_mov_b32 v48, 163328
    ds_read_b128 v[40:43], v48
    ds_read_b128 v[44:47], v48 offset:16
    ds_read_b64 v[32:33], v30 offset:0
    ds_read_b64 v[34:35], v30 offset:128
    ds_read_b64 v[36:37], v30 offset:256
    ds_read_b64 v[38:39], v30 offset:384
    s_waitcnt lgkmcnt(4)
    v_add_f32 v40, v40, v42
    v_add_f32 v44, v44, v46
    v_add_f32 v41, v41, v43
    v_add_f32 v45, v45, v47
    v_add_f32 v42, v40, v44
    v_add_f32 v40, v41, v45
    v_mul_f32 v40, 0x3b124925, v40
    v_mul_f32 v41, 0x3b124925, v42
    v_fma_f32 v41, -v40, v40, v41
    v_max_f32 v41, 0, v41
    v_add_f32 v41, 0x3727c5ac, v41
    v_rsq_f32 v41, v41
    s_waitcnt lgkmcnt(0)
    v_add_f32 v32, v32, v34
    v_add_f32 v36, v36, v38
    v_add_f32 v33, v33, v35
    v_add_f32 v37, v37, v39
    v_add_f32 v32, v32, v36
    v_add_f32 v33, v33, v37
    v_fma_f32 v32, -v40, v33, v32
    v_mul_f32 v32, v32, v41
    s_lshl_b32 s57, s4, 9
    s_lshl_b32 s58, s5, 5
    v_mov_b32_dpp v33, v32 quad_perm:[1,0,3,2] row_mask:0xf bank_mask:0xf
    s_add_u32 s57, s57, s58
    s_add_u32 s57, s57, 661504
    v_cvt_pk_bf16_f32 v32, v32, v33
    v_lshlrev_b32 v35, 1, v0
    s_mov_b64 exec, 0x5555
    buffer_store_dword v32, v35, s[16:19], s57 offen sc1
    s_mov_b64 exec, -1
S5X_46:
    v_and_b32 v30, 63, v0
    v_lshrrev_b32 v32, 4, v30
    v_lshlrev_b32 v32, 2, v32
    v_and_b32 v30, 3, v30
    v_add_u32 v32, v32, v30
    v_lshlrev_b32 v32, 4, v32
    s_lshl_b32 s46, s4, 9
    s_add_u32 s46, s46, 661504
    v_and_b32 v39, 63, v0
    v_lshlrev_b32 v39, 2, v39
    s_mov_b32 s45, 677888
    v_and_b32 v34, 15, v0
    v_lshlrev_b32 v34, 2, v34
    s_lshl_b32 s47, s4, 6
    s_add_u32 s47, s47, 677888
    s_sleep 13
    s_mov_b32 s56, 0
PL_47:
    buffer_load_dwordx4 v[8:11], v32, s[16:19], s46 offen sc1
    buffer_load_dwordx4 v[12:15], v32, s[16:19], s46 offen offset:256 sc1
    buffer_load_dword v33, v34, s[16:19], s47 offen sc1
    buffer_load_dword v35, v39, s[16:19], s45 offen offset:0 sc1
    buffer_load_dword v36, v39, s[16:19], s45 offen offset:256 sc1
    buffer_load_dword v37, v39, s[16:19], s45 offen offset:512 sc1
    buffer_load_dword v38, v39, s[16:19], s45 offen offset:768 sc1
    s_waitcnt vmcnt(0)
    v_max_u32 v30, v8, v9
    v_max3_u32 v30, v10, v11, v30
    v_max3_u32 v30, v12, v13, v30
    v_max3_u32 v30, v14, v15, v30
    v_max3_u32 v30, v33, v35, v30
    v_max3_u32 v30, v36, v37, v30
    v_max_u32 v30, v38, v30
    v_cmp_eq_u32 vcc, -1, v30
    s_cbranch_vccz PD_48
    s_add_u32 s56, s56, 1
    s_cmp_lt_u32 s56, 65536
    s_sleep 2
    s_cbranch_scc1 PL_47
PD_48:
    v_cmp_eq_u32 vcc, 2, v33
    s_nop 1
    s_and_b32 s66, vcc_lo, 0xff
    s_lshr_b32 s67, vcc_lo, 8
    s_and_b32 s67, s67, 0xff
    s_mov_b32 s40, 0
    s_mov_b32 s41, 0
    v_cmp_eq_u32 vcc, 2, v35
    s_nop 1
    s_andn2_b32 s58, 0x00aa00aa, vcc_lo
    s_bcnt1_i32_b32 s58, s58
    s_add_u32 s40, s40, s58
    s_andn2_b32 s58, 0xaa00aa00, vcc_lo
    s_bcnt1_i32_b32 s58, s58
    s_add_u32 s41, s41, s58
    s_andn2_b32 s58, 0x00aa00aa, vcc_hi
    s_bcnt1_i32_b32 s58, s58
    s_add_u32 s40, s40, s58
    s_andn2_b32 s58, 0xaa00aa00, vcc_hi
    s_bcnt1_i32_b32 s58, s58
    s_add_u32 s41, s41, s58
    v_cmp_eq_u32 vcc, 2, v36
    s_nop 1
    s_andn2_b32 s58, 0x00aa00aa, vcc_lo
    s_bcnt1_i32_b32 s58, s58
    s_add_u32 s40, s40, s58
    s_andn2_b32 s58, 0xaa00aa00, vcc_lo
    s_bcnt1_i32_b32 s58, s58
    s_add_u32 s41, s41, s58
    s_andn2_b32 s58, 0x00aa00aa, vcc_hi
    s_bcnt1_i32_b32 s58, s58
    s_add_u32 s40, s40, s58
    s_andn2_b32 s58, 0xaa00aa00, vcc_hi
    s_bcnt1_i32_b32 s58, s58
    s_add_u32 s41, s41, s58
    v_cmp_eq_u32 vcc, 2, v37
    s_nop 1
    s_andn2_b32 s58, 0x00aa00aa, vcc_lo
    s_bcnt1_i32_b32 s58, s58
    s_add_u32 s40, s40, s58
    s_andn2_b32 s58, 0xaa00aa00, vcc_lo
    s_bcnt1_i32_b32 s58, s58
    s_add_u32 s41, s41, s58
    s_andn2_b32 s58, 0x00aa00aa, vcc_hi
    s_bcnt1_i32_b32 s58, s58
    s_add_u32 s40, s40, s58
    s_andn2_b32 s58, 0xaa00aa00, vcc_hi
    s_bcnt1_i32_b32 s58, s58
    s_add_u32 s41, s41, s58
    v_cmp_eq_u32 vcc, 2, v38
    s_nop 1
    s_andn2_b32 s58, 0x00aa00aa, vcc_lo
    s_bcnt1_i32_b32 s58, s58
    s_add_u32 s40, s40, s58
    s_andn2_b32 s58, 0xaa00aa00, vcc_lo
    s_bcnt1_i32_b32 s58, s58
    s_add_u32 s41, s41, s58
    s_andn2_b32 s58, 0x00aa00aa, vcc_hi
    s_bcnt1_i32_b32 s58, s58
    s_add_u32 s40, s40, s58
    s_andn2_b32 s58, 0xaa00aa00, vcc_hi
    s_bcnt1_i32_b32 s58, s58
    s_add_u32 s41, s41, s58
    s_andn2_b32 s57, 0xaa, s66
    s_bcnt1_i32_b32 s57, s57
    s_cmp_gt_u32 s40, 32
    s_cselect_b32 s58, 3, 0
    s_add_u32 s57, s57, s58
    s_mov_b32 s58, 0xaa
    s_mov_b32 s59, 0x55
    s_cmp_gt_u32 s57, 3
    s_cselect_b32 s66, s59, s58
    s_andn2_b32 s57, 0xaa, s67
    s_bcnt1_i32_b32 s57, s57
    s_cmp_gt_u32 s41, 32
    s_cselect_b32 s58, 3, 0
    s_add_u32 s57, s57, s58
    s_mov_b32 s58, 0xaa
    s_mov_b32 s59, 0x55
    s_cmp_gt_u32 s57, 3
    s_cselect_b32 s67, s59, s58
    s_setpc_b64 s[70:71]
TAIL4:
    s_cmp_ge_u32 s54, 56
    s_cbranch_scc1 S4X_49
    s_add_u32 s47, s55, 8192
    v_and_b32 v30, 63, v0
    v_lshrrev_b32 v28, 4, v30
    v_bfe_u32 v27, v30, 2, 2
    v_lshl_add_u32 v27, v28, 3, v27
    v_mul_u32_u24 v27, 16, v27
    v_and_b32 v28, 1, v30
    v_lshl_add_u32 v27, v28, 3, v27
    v_add_u32 v27, s47, v27
    ds_read_b64_tr_b16 v[120:121], v27 offset:0
    ds_read_b64_tr_b16 v[122:123], v27 offset:64
    ds_read_b64_tr_b16 v[124:125], v27 offset:512
    ds_read_b64_tr_b16 v[126:127], v27 offset:576
    ds_read_b64_tr_b16 v[128:129], v27 offset:1024
    ds_read_b64_tr_b16 v[130:131], v27 offset:1088
    ds_read_b64_tr_b16 v[132:133], v27 offset:1536
    ds_read_b64_tr_b16 v[134:135], v27 offset:1600
    ds_read_b64_tr_b16 v[136:137], v27 offset:2048
    ds_read_b64_tr_b16 v[138:139], v27 offset:2112
    ds_read_b64_tr_b16 v[140:141], v27 offset:2560
    ds_read_b64_tr_b16 v[142:143], v27 offset:2624
    ds_read_b64_tr_b16 v[144:145], v27 offset:3072
    ds_read_b64_tr_b16 v[146:147], v27 offset:3136
    ds_read_b64_tr_b16 v[148:149], v27 offset:3584
    ds_read_b64_tr_b16 v[150:151], v27 offset:3648
    ds_read_b64_tr_b16 v[152:153], v27 offset:4096
    ds_read_b64_tr_b16 v[154:155], v27 offset:4160
    ds_read_b64_tr_b16 v[156:157], v27 offset:4608
    ds_read_b64_tr_b16 v[158:159], v27 offset:4672
    ds_read_b64_tr_b16 v[160:161], v27 offset:5120
    ds_read_b64_tr_b16 v[162:163], v27 offset:5184
    ds_read_b64_tr_b16 v[164:165], v27 offset:5632
    ds_read_b64_tr_b16 v[166:167], v27 offset:5696
    ds_read_b64_tr_b16 v[168:169], v27 offset:6144
    ds_read_b64_tr_b16 v[170:171], v27 offset:6208
    ds_read_b64_tr_b16 v[172:173], v27 offset:6656
    ds_read_b64_tr_b16 v[174:175], v27 offset:6720
    v_bfe_u32 v25, v0, 4, 2
    v_lshlrev_b32 v25, 4, v25
    v_and_b32 v28, 15, v0
    v_lshlrev_b32 v28, 3, v28
    s_lshl_b32 s57, s3, 7
    s_add_u32 s57, s57, 162816
    v_add_u32 v28, s57, v28
    s_mul_i32 s46, s3, 896
    s_add_u32 s46, s46, 650752
    s_sleep 16
    s_mov_b32 s56, 0
PL_50:
    buffer_load_dwordx4 v[64:67], v25, s[16:19], s46 offen offset:0 sc1
    buffer_load_dwordx4 v[68:71], v25, s[16:19], s46 offen offset:64 sc1
    buffer_load_dwordx4 v[72:75], v25, s[16:19], s46 offen offset:128 sc1
    buffer_load_dwordx4 v[76:79], v25, s[16:19], s46 offen offset:192 sc1
    buffer_load_dwordx4 v[80:83], v25, s[16:19], s46 offen offset:256 sc1
    buffer_load_dwordx4 v[84:87], v25, s[16:19], s46 offen offset:320 sc1
    buffer_load_dwordx4 v[88:91], v25, s[16:19], s46 offen offset:384 sc1
    buffer_load_dwordx4 v[92:95], v25, s[16:19], s46 offen offset:448 sc1
    buffer_load_dwordx4 v[96:99], v25, s[16:19], s46 offen offset:512 sc1
    buffer_load_dwordx4 v[100:103], v25, s[16:19], s46 offen offset:576 sc1
    buffer_load_dwordx4 v[104:107], v25, s[16:19], s46 offen offset:640 sc1
    buffer_load_dwordx4 v[108:111], v25, s[16:19], s46 offen offset:704 sc1
    buffer_load_dwordx4 v[112:115], v25, s[16:19], s46 offen offset:768 sc1
    buffer_load_dwordx4 v[116:119], v25, s[16:19], s46 offen offset:832 sc1
    s_waitcnt vmcnt(0)
    v_max_u32 v30, v64, v65
    v_max3_u32 v30, v66, v67, v30
    v_max3_u32 v30, v68, v69, v30
    v_max3_u32 v30, v70, v71, v30
    v_max3_u32 v30, v72, v73, v30
    v_max3_u32 v30, v74, v75, v30
    v_max3_u32 v30, v76, v77, v30
    v_max3_u32 v30, v78, v79, v30
    v_max3_u32 v30, v80, v81, v30
    v_max3_u32 v30, v82, v83, v30
    v_max3_u32 v30, v84, v85, v30
    v_max3_u32 v30, v86, v87, v30
    v_max3_u32 v30, v88, v89, v30
    v_max3_u32 v30, v90, v91, v30
    v_max3_u32 v30, v92, v93, v30
    v_max3_u32 v30, v94, v95, v30
    v_max3_u32 v30, v96, v97, v30
    v_max3_u32 v30, v98, v99, v30
    v_max3_u32 v30, v100, v101, v30
    v_max3_u32 v30, v102, v103, v30
    v_max3_u32 v30, v104, v105, v30
    v_max3_u32 v30, v106, v107, v30
    v_max3_u32 v30, v108, v109, v30
    v_max3_u32 v30, v110, v111, v30
    v_max3_u32 v30, v112, v113, v30
    v_max3_u32 v30, v114, v115, v30
    v_max3_u32 v30, v116, v117, v30
    v_max3_u32 v30, v118, v119, v30
    v_cmp_eq_u32 vcc, -1, v30
    s_cbranch_vccz PD_51
    s_add_u32 s56, s56, 1
    s_cmp_lt_u32 s56, 65536
    s_sleep 2
    s_cbranch_scc1 PL_50
PD_51:
    s_waitcnt lgkmcnt(0)
    v_mfma_f32_16x16x32_bf16 v[32:35], v[64:67], v[120:123], 0
    v_mfma_f32_16x16x32_bf16 v[36:39], v[68:71], v[124:127], 0
    v_mfma_f32_16x16x32_bf16 v[32:35], v[72:75], v[128:131], v[32:35]
    v_mfma_f32_16x16x32_bf16 v[36:39], v[76:79], v[132:135], v[36:39]
    v_mfma_f32_16x16x32_bf16 v[32:35], v[80:83], v[136:139], v[32:35]
    v_mfma_f32_16x16x32_bf16 v[36:39], v[84:87], v[140:143], v[36:39]
    v_mfma_f32_16x16x32_bf16 v[32:35], v[88:91], v[144:147], v[32:35]
    v_mfma_f32_16x16x32_bf16 v[36:39], v[92:95], v[148:151], v[36:39]
    v_mfma_f32_16x16x32_bf16 v[32:35], v[96:99], v[152:155], v[32:35]
    v_mfma_f32_16x16x32_bf16 v[36:39], v[100:103], v[156:159], v[36:39]
    v_mfma_f32_16x16x32_bf16 v[32:35], v[104:107], v[160:163], v[32:35]
    v_mfma_f32_16x16x32_bf16 v[36:39], v[108:111], v[164:167], v[36:39]
    v_mfma_f32_16x16x32_bf16 v[32:35], v[112:115], v[168:171], v[32:35]
    v_mfma_f32_16x16x32_bf16 v[36:39], v[116:119], v[172:175], v[36:39]
GK_52:
    s_nop 7
    v_add_f32 v32, v32, v36
    s_mov_b64 exec, 0xffff
    ds_write_b64 v28, v[32:33]
    s_mov_b64 exec, -1
    s_waitcnt lgkmcnt(0)
    s_barrier
    s_cmp_lg_u32 s3, 0
    s_cbranch_scc1 S4X_49
    v_and_b32 v42, 7, v0
    v_lshlrev_b32 v42, 1, v42
    s_lshl_b32 s57, s54, 4
    s_add_u32 s57, s57, 161792
    v_add_u32 v42, s57, v42
    ds_read_u16 v43, v42
    v_and_b32 v30, 15, v0
    v_lshlrev_b32 v30, 3, v30
    v_add_u32 v30, 162816, v30
    ds_read_b64 v[32:33], v30 offset:0
    ds_read_b64 v[34:35], v30 offset:128
    ds_read_b64 v[36:37], v30 offset:256
    ds_read_b64 v[38:39], v30 offset:384
    s_waitcnt lgkmcnt(0)
    v_add_f32 v32, v32, v34
    v_add_f32 v36, v36, v38
    v_add_f32 v33, v33, v35
    v_add_f32 v37, v37, v39
    v_add_f32 v32, v32, v36
    v_add_f32 v33, v33, v37
    v_cvt_pk_bf16_f32 v32, v32, v32
    v_and_b32 v32, 0xffff0000, v32
    v_lshlrev_b32 v43, 16, v43
    v_add_f32 v32, v32, v43
    s_mov_b32 s20, s36
    s_and_b32 s21, s37, 0xffff
    s_mov_b32 s22, 896
    s_mov_b32 s23, 0x20000
    v_mov_b32_dpp v35, v32 quad_perm:[1,0,3,2] row_mask:0xf bank_mask:0xf
    v_lshlrev_b32 v36, 1, v0
    v_cvt_pk_bf16_f32 v32, v32, v35
    s_lshl_b32 s57, s54, 4
    s_mov_b64 exec, 0x55
    buffer_store_dword v32, v36, s[20:23], s57 offen
    s_mov_b64 exec, -1
S4X_49:
FIN:
END:
    s_endpgm
SLOW:
    v_mov_b32 v30, v27
    s_nop 1
    v_max_f32_dpp v30, v30, v30 row_ror:4 row_mask:0xf bank_mask:0xf
    s_nop 1
    v_max_f32_dpp v30, v30, v30 row_ror:8 row_mask:0xf bank_mask:0xf
    s_nop 1
    v_readlane_b32 s40, v30, 0
    v_readlane_b32 s41, v30, 16
    v_readlane_b32 s42, v30, 32
    v_readlane_b32 s43, v30, 48
    s_nop 1
    v_mov_b32 v30, s40
    v_max_f32 v30, s41, v30
    v_max_f32 v30, s42, v30
    v_max_f32 v30, s43, v30
    v_max_f32 v24, v24, v30
    v_mul_f32 v30, s53, v24
    v_sub_f32 v28, v25, v30
    v_exp_f32 v28, v28
    v_mov_b32 v25, v30
    s_nop 7
    v_mul_f32 v16, v16, v28
    v_mul_f32 v17, v17, v28
    v_mul_f32 v18, v18, v28
    v_mul_f32 v19, v19, v28
    v_mul_f32 v20, v20, v28
    v_mul_f32 v21, v21, v28
    v_mul_f32 v22, v22, v28
    v_mul_f32 v23, v23, v28
    v_mul_f32 v26, v26, v28
    s_setpc_b64 s[50:51]
QK0:
    v_mfma_f32_16x16x32_bf16 v[32:35], v[64:67], v[8:11], 0
    v_mfma_f32_16x16x32_bf16 v[36:39], v[72:75], v[8:11], 0
    v_mfma_f32_16x16x32_bf16 v[40:43], v[80:83], v[8:11], 0
    v_mfma_f32_16x16x32_bf16 v[44:47], v[88:91], v[8:11], 0
    v_mfma_f32_16x16x32_bf16 v[32:35], v[68:71], v[12:15], v[32:35]
    v_mfma_f32_16x16x32_bf16 v[36:39], v[76:79], v[12:15], v[36:39]
    v_mfma_f32_16x16x32_bf16 v[40:43], v[84:87], v[12:15], v[40:43]
    v_mfma_f32_16x16x32_bf16 v[44:47], v[92:95], v[12:15], v[44:47]
    s_bitcmp1_b32 s64, 0
    s_cbranch_scc0 LD_54
    s_bitcmp1_b32 s64, 1
    s_cbranch_scc0 LN_53
    buffer_load_dwordx4 v[64:67], v1, s[8:11], s44 offen offset:0
    buffer_load_dwordx4 v[68:71], v1, s[8:11], s44 offen offset:256
    buffer_load_dwordx4 v[72:75], v1, s[8:11], s44 offen offset:2048
    buffer_load_dwordx4 v[76:79], v1, s[8:11], s44 offen offset:2304
    buffer_load_dwordx4 v[80:83], v1, s[8:11], s45 offen offset:0
    buffer_load_dwordx4 v[84:87], v1, s[8:11], s45 offen offset:256
    buffer_load_dwordx4 v[88:91], v1, s[8:11], s45 offen offset:2048
    buffer_load_dwordx4 v[92:95], v1, s[8:11], s45 offen offset:2304
    s_branch LD_54
LN_53:
    buffer_load_dwordx4 v[64:67], v1, s[8:11], s44 offen offset:0 nt
    buffer_load_dwordx4 v[68:71], v1, s[8:11], s44 offen offset:256 nt
    buffer_load_dwordx4 v[72:75], v1, s[8:11], s44 offen offset:2048 nt
    buffer_load_dwordx4 v[76:79], v1, s[8:11], s44 offen offset:2304 nt
    buffer_load_dwordx4 v[80:83], v1, s[8:11], s45 offen offset:0 nt
    buffer_load_dwordx4 v[84:87], v1, s[8:11], s45 offen offset:256 nt
    buffer_load_dwordx4 v[88:91], v1, s[8:11], s45 offen offset:2048 nt
    buffer_load_dwordx4 v[92:95], v1, s[8:11], s45 offen offset:2304 nt
LD_54:
    s_nop 7
    v_mov_b32_dpp v32, v32 quad_perm:[0,0,0,0] row_mask:0xf bank_mask:0xf
    v_mov_b32_dpp v36, v36 quad_perm:[0,0,0,0] row_mask:0xf bank_mask:0xf
    v_mov_b32_dpp v40, v40 quad_perm:[0,0,0,0] row_mask:0xf bank_mask:0xf
    v_mov_b32_dpp v44, v44 quad_perm:[0,0,0,0] row_mask:0xf bank_mask:0xf
    v_add_f32_dpp v32, v33, v32 quad_perm:[1,1,1,1] row_mask:0xf bank_mask:0xf
    v_add_f32_dpp v36, v37, v36 quad_perm:[1,1,1,1] row_mask:0xf bank_mask:0xf
    v_add_f32_dpp v40, v41, v40 quad_perm:[1,1,1,1] row_mask:0xf bank_mask:0xf
    v_add_f32_dpp v44, v45, v44 quad_perm:[1,1,1,1] row_mask:0xf bank_mask:0xf
    v_add_f32_dpp v32, v34, v32 quad_perm:[2,2,2,2] row_mask:0xf bank_mask:0xf
    v_add_f32_dpp v36, v38, v36 quad_perm:[2,2,2,2] row_mask:0xf bank_mask:0xf
    v_add_f32_dpp v40, v42, v40 quad_perm:[2,2,2,2] row_mask:0xf bank_mask:0xf
    v_add_f32_dpp v44, v46, v44 quad_perm:[2,2,2,2] row_mask:0xf bank_mask:0xf
    v_add_f32_dpp v27, v35, v32 quad_perm:[3,3,3,3] row_mask:0xf bank_mask:0x1
    v_add_f32_dpp v27, v39, v36 quad_perm:[3,3,3,3] row_mask:0xf bank_mask:0x2
    v_add_f32_dpp v27, v43, v40 quad_perm:[3,3,3,3] row_mask:0xf bank_mask:0x4
    v_add_f32_dpp v27, v47, v44 quad_perm:[3,3,3,3] row_mask:0xf bank_mask:0x8
    v_cvt_pk_bf16_f32 v27, v27, v27
    v_and_b32 v27, 0xffff0000, v27
    s_bitcmp1_b32 s64, 2
    s_cbranch_scc0 QP_55
    s_mov_b32 exec_lo, 0x11111111
    s_mov_b32 exec_hi, 0x11111111
    buffer_store_dword v27, v48, s[16:19], s47 offen sc1
    s_mov_b64 exec, -1
QP_55:
    s_setpc_b64 s[70:71]
QK1:
    v_mfma_f32_16x16x32_bf16 v[32:35], v[128:131], v[8:11], 0
    v_mfma_f32_16x16x32_bf16 v[36:39], v[136:139], v[8:11], 0
    v_mfma_f32_16x16x32_bf16 v[40:43], v[144:147], v[8:11], 0
    v_mfma_f32_16x16x32_bf16 v[44:47], v[152:155], v[8:11], 0
    v_mfma_f32_16x16x32_bf16 v[32:35], v[132:135], v[12:15], v[32:35]
    v_mfma_f32_16x16x32_bf16 v[36:39], v[140:143], v[12:15], v[36:39]
    v_mfma_f32_16x16x32_bf16 v[40:43], v[148:151], v[12:15], v[40:43]
    v_mfma_f32_16x16x32_bf16 v[44:47], v[156:159], v[12:15], v[44:47]
    s_bitcmp1_b32 s64, 0
    s_cbranch_scc0 LD_57
    s_bitcmp1_b32 s64, 1
    s_cbranch_scc0 LN_56
    buffer_load_dwordx4 v[128:131], v1, s[8:11], s44 offen offset:0
    buffer_load_dwordx4 v[132:135], v1, s[8:11], s44 offen offset:256
    buffer_load_dwordx4 v[136:139], v1, s[8:11], s44 offen offset:2048
    buffer_load_dwordx4 v[140:143], v1, s[8:11], s44 offen offset:2304
    buffer_load_dwordx4 v[144:147], v1, s[8:11], s45 offen offset:0
    buffer_load_dwordx4 v[148:151], v1, s[8:11], s45 offen offset:256
    buffer_load_dwordx4 v[152:155], v1, s[8:11], s45 offen offset:2048
    buffer_load_dwordx4 v[156:159], v1, s[8:11], s45 offen offset:2304
    s_branch LD_57
LN_56:
    buffer_load_dwordx4 v[128:131], v1, s[8:11], s44 offen offset:0 nt
    buffer_load_dwordx4 v[132:135], v1, s[8:11], s44 offen offset:256 nt
    buffer_load_dwordx4 v[136:139], v1, s[8:11], s44 offen offset:2048 nt
    buffer_load_dwordx4 v[140:143], v1, s[8:11], s44 offen offset:2304 nt
    buffer_load_dwordx4 v[144:147], v1, s[8:11], s45 offen offset:0 nt
    buffer_load_dwordx4 v[148:151], v1, s[8:11], s45 offen offset:256 nt
    buffer_load_dwordx4 v[152:155], v1, s[8:11], s45 offen offset:2048 nt
    buffer_load_dwordx4 v[156:159], v1, s[8:11], s45 offen offset:2304 nt
LD_57:
    s_nop 7
    v_mov_b32_dpp v32, v32 quad_perm:[0,0,0,0] row_mask:0xf bank_mask:0xf
    v_mov_b32_dpp v36, v36 quad_perm:[0,0,0,0] row_mask:0xf bank_mask:0xf
    v_mov_b32_dpp v40, v40 quad_perm:[0,0,0,0] row_mask:0xf bank_mask:0xf
    v_mov_b32_dpp v44, v44 quad_perm:[0,0,0,0] row_mask:0xf bank_mask:0xf
    v_add_f32_dpp v32, v33, v32 quad_perm:[1,1,1,1] row_mask:0xf bank_mask:0xf
    v_add_f32_dpp v36, v37, v36 quad_perm:[1,1,1,1] row_mask:0xf bank_mask:0xf
    v_add_f32_dpp v40, v41, v40 quad_perm:[1,1,1,1] row_mask:0xf bank_mask:0xf
    v_add_f32_dpp v44, v45, v44 quad_perm:[1,1,1,1] row_mask:0xf bank_mask:0xf
    v_add_f32_dpp v32, v34, v32 quad_perm:[2,2,2,2] row_mask:0xf bank_mask:0xf
    v_add_f32_dpp v36, v38, v36 quad_perm:[2,2,2,2] row_mask:0xf bank_mask:0xf
    v_add_f32_dpp v40, v42, v40 quad_perm:[2,2,2,2] row_mask:0xf bank_mask:0xf
    v_add_f32_dpp v44, v46, v44 quad_perm:[2,2,2,2] row_mask:0xf bank_mask:0xf
    v_add_f32_dpp v27, v35, v32 quad_perm:[3,3,3,3] row_mask:0xf bank_mask:0x1
    v_add_f32_dpp v27, v39, v36 quad_perm:[3,3,3,3] row_mask:0xf bank_mask:0x2
    v_add_f32_dpp v27, v43, v40 quad_perm:[3,3,3,3] row_mask:0xf bank_mask:0x4
    v_add_f32_dpp v27, v47, v44 quad_perm:[3,3,3,3] row_mask:0xf bank_mask:0x8
    v_cvt_pk_bf16_f32 v27, v27, v27
    v_and_b32 v27, 0xffff0000, v27
    s_bitcmp1_b32 s64, 2
    s_cbranch_scc0 QP_58
    s_mov_b32 exec_lo, 0x11111111
    s_mov_b32 exec_hi, 0x11111111
    buffer_store_dword v27, v48, s[16:19], s47 offen sc1
    s_mov_b64 exec, -1
QP_58:
    s_setpc_b64 s[70:71]
PV0:
    s_bitcmp1_b32 s64, 3
    s_cbranch_scc0 PO_59
    s_mov_b32 s56, 0
PP_60:
    v_cmp_eq_u32 vcc, -1, v49
    s_cbranch_vccz PK_61
    buffer_load_dword v49, v48, s[16:19], s65 offen sc1
    s_waitcnt vmcnt(0)
    s_add_u32 s56, s56, 1
    s_cmp_lt_u32 s56, 65536
    s_cbranch_scc1 PP_60
PK_61:
    v_mov_b32 v27, v49
PO_59:
    v_cmp_gt_f32 vcc, v27, v24
    s_cbranch_vccz SK_62
    s_swappc_b64 s[50:51], s[48:49]
SK_62:
    v_fma_f32 v28, v27, s53, -v25
    v_exp_f32 v28, v28
    s_nop 0
    v_add_f32 v26, v26, v28
    v_cvt_pk_bf16_f32 v29, v28, v28
    s_nop 1
    v_and_b32_dpp v32, v29, v4 row_newbcast:0 row_mask:0xf bank_mask:0xf
    v_and_b32_dpp v33, v29, v5 row_newbcast:0 row_mask:0xf bank_mask:0xf
    v_and_b32_dpp v34, v29, v6 row_newbcast:0 row_mask:0xf bank_mask:0xf
    v_and_b32_dpp v35, v29, v7 row_newbcast:0 row_mask:0xf bank_mask:0xf
    v_and_b32_dpp v36, v29, v4 row_newbcast:4 row_mask:0xf bank_mask:0xf
    v_and_b32_dpp v37, v29, v5 row_newbcast:4 row_mask:0xf bank_mask:0xf
    v_and_b32_dpp v38, v29, v6 row_newbcast:4 row_mask:0xf bank_mask:0xf
    v_and_b32_dpp v39, v29, v7 row_newbcast:4 row_mask:0xf bank_mask:0xf
    v_mfma_f32_16x16x32_bf16 v[16:19], v[32:35], v[96:99], v[16:19]
    v_mfma_f32_16x16x32_bf16 v[20:23], v[32:35], v[100:103], v[20:23]
    v_and_b32_dpp v32, v29, v4 row_newbcast:8 row_mask:0xf bank_mask:0xf
    v_and_b32_dpp v33, v29, v5 row_newbcast:8 row_mask:0xf bank_mask:0xf
    v_and_b32_dpp v34, v29, v6 row_newbcast:8 row_mask:0xf bank_mask:0xf
    v_and_b32_dpp v35, v29, v7 row_newbcast:8 row_mask:0xf bank_mask:0xf
    v_mfma_f32_16x16x32_bf16 v[16:19], v[36:39], v[104:107], v[16:19]
    v_mfma_f32_16x16x32_bf16 v[20:23], v[36:39], v[108:111], v[20:23]
    v_and_b32_dpp v36, v29, v4 row_newbcast:12 row_mask:0xf bank_mask:0xf
    v_and_b32_dpp v37, v29, v5 row_newbcast:12 row_mask:0xf bank_mask:0xf
    v_and_b32_dpp v38, v29, v6 row_newbcast:12 row_mask:0xf bank_mask:0xf
    v_and_b32_dpp v39, v29, v7 row_newbcast:12 row_mask:0xf bank_mask:0xf
    v_mfma_f32_16x16x32_bf16 v[16:19], v[32:35], v[112:115], v[16:19]
    v_mfma_f32_16x16x32_bf16 v[20:23], v[32:35], v[116:119], v[20:23]
    v_mfma_f32_16x16x32_bf16 v[16:19], v[36:39], v[120:123], v[16:19]
    v_mfma_f32_16x16x32_bf16 v[20:23], v[36:39], v[124:127], v[20:23]
    s_bitcmp1_b32 s64, 0
    s_cbranch_scc0 LD_64
    s_bitcmp1_b32 s64, 2
    s_cbranch_scc0 LC_65
    buffer_load_dword v49, v48, s[16:19], s46 offen sc1
LC_65:
    s_bitcmp1_b32 s64, 1
    s_cbranch_scc0 LN_63
    buffer_load_dwordx4 v[96:99], v2, s[12:15], s44 offen offset:0
    buffer_load_dwordx4 v[100:103], v2, s[12:15], s44 offen offset:256
    buffer_load_dwordx4 v[104:107], v2, s[12:15], s44 offen offset:2048
    buffer_load_dwordx4 v[108:111], v2, s[12:15], s44 offen offset:2304
    buffer_load_dwordx4 v[112:115], v2, s[12:15], s45 offen offset:0
    buffer_load_dwordx4 v[116:119], v2, s[12:15], s45 offen offset:256
    buffer_load_dwordx4 v[120:123], v2, s[12:15], s45 offen offset:2048
    buffer_load_dwordx4 v[124:127], v2, s[12:15], s45 offen offset:2304
    s_branch LD_64
LN_63:
    buffer_load_dwordx4 v[96:99], v2, s[12:15], s44 offen offset:0 nt
    buffer_load_dwordx4 v[100:103], v2, s[12:15], s44 offen offset:256 nt
    buffer_load_dwordx4 v[104:107], v2, s[12:15], s44 offen offset:2048 nt
    buffer_load_dwordx4 v[108:111], v2, s[12:15], s44 offen offset:2304 nt
    buffer_load_dwordx4 v[112:115], v2, s[12:15], s45 offen offset:0 nt
    buffer_load_dwordx4 v[116:119], v2, s[12:15], s45 offen offset:256 nt
    buffer_load_dwordx4 v[120:123], v2, s[12:15], s45 offen offset:2048 nt
    buffer_load_dwordx4 v[124:127], v2, s[12:15], s45 offen offset:2304 nt
LD_64:
    s_setpc_b64 s[70:71]
PV1:
    s_bitcmp1_b32 s64, 3
    s_cbranch_scc0 PO_66
    s_mov_b32 s56, 0
PP_67:
    v_cmp_eq_u32 vcc, -1, v50
    s_cbranch_vccz PK_68
    buffer_load_dword v50, v48, s[16:19], s65 offen sc1
    s_waitcnt vmcnt(0)
    s_add_u32 s56, s56, 1
    s_cmp_lt_u32 s56, 65536
    s_cbranch_scc1 PP_67
PK_68:
    v_mov_b32 v27, v50
PO_66:
    v_cmp_gt_f32 vcc, v27, v24
    s_cbranch_vccz SK_69
    s_swappc_b64 s[50:51], s[48:49]
SK_69:
    v_fma_f32 v28, v27, s53, -v25
    v_exp_f32 v28, v28
    s_nop 0
    v_add_f32 v26, v26, v28
    v_cvt_pk_bf16_f32 v29, v28, v28
    s_nop 1
    v_and_b32_dpp v32, v29, v4 row_newbcast:0 row_mask:0xf bank_mask:0xf
    v_and_b32_dpp v33, v29, v5 row_newbcast:0 row_mask:0xf bank_mask:0xf
    v_and_b32_dpp v34, v29, v6 row_newbcast:0 row_mask:0xf bank_mask:0xf
    v_and_b32_dpp v35, v29, v7 row_newbcast:0 row_mask:0xf bank_mask:0xf
    v_and_b32_dpp v36, v29, v4 row_newbcast:4 row_mask:0xf bank_mask:0xf
    v_and_b32_dpp v37, v29, v5 row_newbcast:4 row_mask:0xf bank_mask:0xf
    v_and_b32_dpp v38, v29, v6 row_newbcast:4 row_mask:0xf bank_mask:0xf
    v_and_b32_dpp v39, v29, v7 row_newbcast:4 row_mask:0xf bank_mask:0xf
    v_mfma_f32_16x16x32_bf16 v[16:19], v[32:35], v[160:163], v[16:19]
    v_mfma_f32_16x16x32_bf16 v[20:23], v[32:35], v[164:167], v[20:23]
    v_and_b32_dpp v32, v29, v4 row_newbcast:8 row_mask:0xf bank_mask:0xf
    v_and_b32_dpp v33, v29, v5 row_newbcast:8 row_mask:0xf bank_mask:0xf
    v_and_b32_dpp v34, v29, v6 row_newbcast:8 row_mask:0xf bank_mask:0xf
    v_and_b32_dpp v35, v29, v7 row_newbcast:8 row_mask:0xf bank_mask:0xf
    v_mfma_f32_16x16x32_bf16 v[16:19], v[36:39], v[168:171], v[16:19]
    v_mfma_f32_16x16x32_bf16 v[20:23], v[36:39], v[172:175], v[20:23]
    v_and_b32_dpp v36, v29, v4 row_newbcast:12 row_mask:0xf bank_mask:0xf
    v_and_b32_dpp v37, v29, v5 row_newbcast:12 row_mask:0xf bank_mask:0xf
    v_and_b32_dpp v38, v29, v6 row_newbcast:12 row_mask:0xf bank_mask:0xf
    v_and_b32_dpp v39, v29, v7 row_newbcast:12 row_mask:0xf bank_mask:0xf
    v_mfma_f32_16x16x32_bf16 v[16:19], v[32:35], v[176:179], v[16:19]
    v_mfma_f32_16x16x32_bf16 v[20:23], v[32:35], v[180:183], v[20:23]
    v_mfma_f32_16x16x32_bf16 v[16:19], v[36:39], v[184:187], v[16:19]
    v_mfma_f32_16x16x32_bf16 v[20:23], v[36:39], v[188:191], v[20:23]
    s_bitcmp1_b32 s64, 0
    s_cbranch_scc0 LD_71
    s_bitcmp1_b32 s64, 2
    s_cbranch_scc0 LC_72
    buffer_load_dword v50, v48, s[16:19], s46 offen sc1
LC_72:
    s_bitcmp1_b32 s64, 1
    s_cbranch_scc0 LN_70
    buffer_load_dwordx4 v[160:163], v2, s[12:15], s44 offen offset:0
    buffer_load_dwordx4 v[164:167], v2, s[12:15], s44 offen offset:256
    buffer_load_dwordx4 v[168:171], v2, s[12:15], s44 offen offset:2048
    buffer_load_dwordx4 v[172:175], v2, s[12:15], s44 offen offset:2304
    buffer_load_dwordx4 v[176:179], v2, s[12:15], s45 offen offset:0
    buffer_load_dwordx4 v[180:183], v2, s[12:15], s45 offen offset:256
    buffer_load_dwordx4 v[184:187], v2, s[12:15], s45 offen offset:2048
    buffer_load_dwordx4 v[188:191], v2, s[12:15], s45 offen offset:2304
    s_branch LD_71
LN_70:
    buffer_load_dwordx4 v[160:163], v2, s[12:15], s44 offen offset:0 nt
    buffer_load_dwordx4 v[164:167], v2, s[12:15], s44 offen offset:256 nt
    buffer_load_dwordx4 v[168:171], v2, s[12:15], s44 offen offset:2048 nt
    buffer_load_dwordx4 v[172:175], v2, s[12:15], s44 offen offset:2304 nt
    buffer_load_dwordx4 v[176:179], v2, s[12:15], s45 offen offset:0 nt
    buffer_load_dwordx4 v[180:183], v2, s[12:15], s45 offen offset:256 nt
    buffer_load_dwordx4 v[184:187], v2, s[12:15], s45 offen offset:2048 nt
    buffer_load_dwordx4 v[188:191], v2, s[12:15], s45 offen offset:2304 nt
LD_71:
    s_setpc_b64 s[70:71]
HELDA:
    ds_read_b128 v[48:51], v3 offset:0
    ds_read_b128 v[52:55], v3 offset:1024
    ds_read_b128 v[56:59], v3 offset:2048
    ds_read_b128 v[60:63], v3 offset:3072
    s_waitcnt lgkmcnt(3)
    v_mfma_f32_16x16x32_bf16 v[32:35], v[48:51], v[8:11], 0
    s_waitcnt lgkmcnt(2)
    v_mfma_f32_16x16x32_bf16 v[32:35], v[52:55], v[12:15], v[32:35]
    s_waitcnt lgkmcnt(1)
    v_mfma_f32_16x16x32_bf16 v[36:39], v[56:59], v[8:11], 0
    s_waitcnt lgkmcnt(0)
    v_mfma_f32_16x16x32_bf16 v[36:39], v[60:63], v[12:15], v[36:39]
    ds_read_b128 v[48:51], v3 offset:4096
    ds_read_b128 v[52:55], v3 offset:5120
    ds_read_b128 v[56:59], v3 offset:6144
    ds_read_b128 v[60:63], v3 offset:7168
    s_waitcnt lgkmcnt(3)
    v_mfma_f32_16x16x32_bf16 v[40:43], v[48:51], v[8:11], 0
    s_waitcnt lgkmcnt(2)
    v_mfma_f32_16x16x32_bf16 v[40:43], v[52:55], v[12:15], v[40:43]
    s_waitcnt lgkmcnt(1)
    v_mfma_f32_16x16x32_bf16 v[44:47], v[56:59], v[8:11], 0
    s_waitcnt lgkmcnt(0)
    v_mfma_f32_16x16x32_bf16 v[44:47], v[60:63], v[12:15], v[44:47]
    s_nop 7
    v_mov_b32_dpp v32, v32 quad_perm:[0,0,0,0] row_mask:0xf bank_mask:0xf
    v_mov_b32_dpp v36, v36 quad_perm:[0,0,0,0] row_mask:0xf bank_mask:0xf
    v_mov_b32_dpp v40, v40 quad_perm:[0,0,0,0] row_mask:0xf bank_mask:0xf
    v_mov_b32_dpp v44, v44 quad_perm:[0,0,0,0] row_mask:0xf bank_mask:0xf
    v_add_f32_dpp v32, v33, v32 quad_perm:[1,1,1,1] row_mask:0xf bank_mask:0xf
    v_add_f32_dpp v36, v37, v36 quad_perm:[1,1,1,1] row_mask:0xf bank_mask:0xf
    v_add_f32_dpp v40, v41, v40 quad_perm:[1,1,1,1] row_mask:0xf bank_mask:0xf
    v_add_f32_dpp v44, v45, v44 quad_perm:[1,1,1,1] row_mask:0xf bank_mask:0xf
    v_add_f32_dpp v32, v34, v32 quad_perm:[2,2,2,2] row_mask:0xf bank_mask:0xf
    v_add_f32_dpp v36, v38, v36 quad_perm:[2,2,2,2] row_mask:0xf bank_mask:0xf
    v_add_f32_dpp v40, v42, v40 quad_perm:[2,2,2,2] row_mask:0xf bank_mask:0xf
    v_add_f32_dpp v44, v46, v44 quad_perm:[2,2,2,2] row_mask:0xf bank_mask:0xf
    v_add_f32_dpp v27, v35, v32 quad_perm:[3,3,3,3] row_mask:0xf bank_mask:0x1
    v_add_f32_dpp v27, v39, v36 quad_perm:[3,3,3,3] row_mask:0xf bank_mask:0x2
    v_add_f32_dpp v27, v43, v40 quad_perm:[3,3,3,3] row_mask:0xf bank_mask:0x4
    v_add_f32_dpp v27, v47, v44 quad_perm:[3,3,3,3] row_mask:0xf bank_mask:0x8
    v_cvt_pk_bf16_f32 v27, v27, v27
    v_and_b32 v27, 0xffff0000, v27
    v_cmp_gt_f32 vcc, v27, v24
    s_cbranch_vccz SK_73
    s_swappc_b64 s[50:51], s[48:49]
SK_73:
    v_fma_f32 v28, v27, s53, -v25
    v_exp_f32 v28, v28
    s_nop 0
    v_add_f32 v26, v26, v28
    v_cvt_pk_bf16_f32 v29, v28, v28
    s_nop 1
    ds_read_b128 v[48:51], v3 offset:8192
    ds_read_b128 v[52:55], v3 offset:9216
    ds_read_b128 v[56:59], v3 offset:10240
    ds_read_b128 v[60:63], v3 offset:11264
    v_and_b32_dpp v32, v29, v4 row_newbcast:0 row_mask:0xf bank_mask:0xf
    v_and_b32_dpp v33, v29, v5 row_newbcast:0 row_mask:0xf bank_mask:0xf
    v_and_b32_dpp v34, v29, v6 row_newbcast:0 row_mask:0xf bank_mask:0xf
    v_and_b32_dpp v35, v29, v7 row_newbcast:0 row_mask:0xf bank_mask:0xf
    v_and_b32_dpp v36, v29, v4 row_newbcast:4 row_mask:0xf bank_mask:0xf
    v_and_b32_dpp v37, v29, v5 row_newbcast:4 row_mask:0xf bank_mask:0xf
    v_and_b32_dpp v38, v29, v6 row_newbcast:4 row_mask:0xf bank_mask:0xf
    v_and_b32_dpp v39, v29, v7 row_newbcast:4 row_mask:0xf bank_mask:0xf
    s_waitcnt lgkmcnt(2)
    v_mfma_f32_16x16x32_bf16 v[16:19], v[32:35], v[48:51], v[16:19]
    v_mfma_f32_16x16x32_bf16 v[20:23], v[32:35], v[52:55], v[20:23]
    s_waitcnt lgkmcnt(0)
    v_mfma_f32_16x16x32_bf16 v[16:19], v[36:39], v[56:59], v[16:19]
    v_mfma_f32_16x16x32_bf16 v[20:23], v[36:39], v[60:63], v[20:23]
    ds_read_b128 v[48:51], v3 offset:12288
    ds_read_b128 v[52:55], v3 offset:13312
    ds_read_b128 v[56:59], v3 offset:14336
    ds_read_b128 v[60:63], v3 offset:15360
    v_and_b32_dpp v32, v29, v4 row_newbcast:8 row_mask:0xf bank_mask:0xf
    v_and_b32_dpp v33, v29, v5 row_newbcast:8 row_mask:0xf bank_mask:0xf
    v_and_b32_dpp v34, v29, v6 row_newbcast:8 row_mask:0xf bank_mask:0xf
    v_and_b32_dpp v35, v29, v7 row_newbcast:8 row_mask:0xf bank_mask:0xf
    v_and_b32_dpp v36, v29, v4 row_newbcast:12 row_mask:0xf bank_mask:0xf
    v_and_b32_dpp v37, v29, v5 row_newbcast:12 row_mask:0xf bank_mask:0xf
    v_and_b32_dpp v38, v29, v6 row_newbcast:12 row_mask:0xf bank_mask:0xf
    v_and_b32_dpp v39, v29, v7 row_newbcast:12 row_mask:0xf bank_mask:0xf
    s_waitcnt lgkmcnt(2)
    v_mfma_f32_16x16x32_bf16 v[16:19], v[32:35], v[48:51], v[16:19]
    v_mfma_f32_16x16x32_bf16 v[20:23], v[32:35], v[52:55], v[20:23]
    s_waitcnt lgkmcnt(0)
    v_mfma_f32_16x16x32_bf16 v[16:19], v[36:39], v[56:59], v[16:19]
    v_mfma_f32_16x16x32_bf16 v[20:23], v[36:39], v[60:63], v[20:23]
    ds_read_b128 v[48:51], v3 offset:16384
    ds_read_b128 v[52:55], v3 offset:17408
    ds_read_b128 v[56:59], v3 offset:18432
    ds_read_b128 v[60:63], v3 offset:19456
    s_waitcnt lgkmcnt(3)
    v_mfma_f32_16x16x32_bf16 v[32:35], v[48:51], v[8:11], 0
    s_waitcnt lgkmcnt(2)
    v_mfma_f32_16x16x32_bf16 v[32:35], v[52:55], v[12:15], v[32:35]
    s_waitcnt lgkmcnt(1)
    v_mfma_f32_16x16x32_bf16 v[36:39], v[56:59], v[8:11], 0
    s_waitcnt lgkmcnt(0)
    v_mfma_f32_16x16x32_bf16 v[36:39], v[60:63], v[12:15], v[36:39]
    ds_read_b128 v[48:51], v3 offset:20480
    ds_read_b128 v[52:55], v3 offset:21504
    ds_read_b128 v[56:59], v3 offset:22528
    ds_read_b128 v[60:63], v3 offset:23552
    s_waitcnt lgkmcnt(3)
    v_mfma_f32_16x16x32_bf16 v[40:43], v[48:51], v[8:11], 0
    s_waitcnt lgkmcnt(2)
    v_mfma_f32_16x16x32_bf16 v[40:43], v[52:55], v[12:15], v[40:43]
    s_waitcnt lgkmcnt(1)
    v_mfma_f32_16x16x32_bf16 v[44:47], v[56:59], v[8:11], 0
    s_waitcnt lgkmcnt(0)
    v_mfma_f32_16x16x32_bf16 v[44:47], v[60:63], v[12:15], v[44:47]
    s_nop 7
    v_mov_b32_dpp v32, v32 quad_perm:[0,0,0,0] row_mask:0xf bank_mask:0xf
    v_mov_b32_dpp v36, v36 quad_perm:[0,0,0,0] row_mask:0xf bank_mask:0xf
    v_mov_b32_dpp v40, v40 quad_perm:[0,0,0,0] row_mask:0xf bank_mask:0xf
    v_mov_b32_dpp v44, v44 quad_perm:[0,0,0,0] row_mask:0xf bank_mask:0xf
    v_add_f32_dpp v32, v33, v32 quad_perm:[1,1,1,1] row_mask:0xf bank_mask:0xf
    v_add_f32_dpp v36, v37, v36 quad_perm:[1,1,1,1] row_mask:0xf bank_mask:0xf
    v_add_f32_dpp v40, v41, v40 quad_perm:[1,1,1,1] row_mask:0xf bank_mask:0xf
    v_add_f32_dpp v44, v45, v44 quad_perm:[1,1,1,1] row_mask:0xf bank_mask:0xf
    v_add_f32_dpp v32, v34, v32 quad_perm:[2,2,2,2] row_mask:0xf bank_mask:0xf
    v_add_f32_dpp v36, v38, v36 quad_perm:[2,2,2,2] row_mask:0xf bank_mask:0xf
    v_add_f32_dpp v40, v42, v40 quad_perm:[2,2,2,2] row_mask:0xf bank_mask:0xf
    v_add_f32_dpp v44, v46, v44 quad_perm:[2,2,2,2] row_mask:0xf bank_mask:0xf
    v_add_f32_dpp v27, v35, v32 quad_perm:[3,3,3,3] row_mask:0xf bank_mask:0x1
    v_add_f32_dpp v27, v39, v36 quad_perm:[3,3,3,3] row_mask:0xf bank_mask:0x2
    v_add_f32_dpp v27, v43, v40 quad_perm:[3,3,3,3] row_mask:0xf bank_mask:0x4
    v_add_f32_dpp v27, v47, v44 quad_perm:[3,3,3,3] row_mask:0xf bank_mask:0x8
    v_cvt_pk_bf16_f32 v27, v27, v27
    v_and_b32 v27, 0xffff0000, v27
    v_cmp_gt_f32 vcc, v27, v24
    s_cbranch_vccz SK_74
    s_swappc_b64 s[50:51], s[48:49]
SK_74:
    v_fma_f32 v28, v27, s53, -v25
    v_exp_f32 v28, v28
    s_nop 0
    v_add_f32 v26, v26, v28
    v_cvt_pk_bf16_f32 v29, v28, v28
    s_nop 1
    ds_read_b128 v[48:51], v3 offset:24576
    ds_read_b128 v[52:55], v3 offset:25600
    ds_read_b128 v[56:59], v3 offset:26624
    ds_read_b128 v[60:63], v3 offset:27648
    v_and_b32_dpp v32, v29, v4 row_newbcast:0 row_mask:0xf bank_mask:0xf
    v_and_b32_dpp v33, v29, v5 row_newbcast:0 row_mask:0xf bank_mask:0xf
    v_and_b32_dpp v34, v29, v6 row_newbcast:0 row_mask:0xf bank_mask:0xf
    v_and_b32_dpp v35, v29, v7 row_newbcast:0 row_mask:0xf bank_mask:0xf
    v_and_b32_dpp v36, v29, v4 row_newbcast:4 row_mask:0xf bank_mask:0xf
    v_and_b32_dpp v37, v29, v5 row_newbcast:4 row_mask:0xf bank_mask:0xf
    v_and_b32_dpp v38, v29, v6 row_newbcast:4 row_mask:0xf bank_mask:0xf
    v_and_b32_dpp v39, v29, v7 row_newbcast:4 row_mask:0xf bank_mask:0xf
    s_waitcnt lgkmcnt(2)
    v_mfma_f32_16x16x32_bf16 v[16:19], v[32:35], v[48:51], v[16:19]
    v_mfma_f32_16x16x32_bf16 v[20:23], v[32:35], v[52:55], v[20:23]
    s_waitcnt lgkmcnt(0)
    v_mfma_f32_16x16x32_bf16 v[16:19], v[36:39], v[56:59], v[16:19]
    v_mfma_f32_16x16x32_bf16 v[20:23], v[36:39], v[60:63], v[20:23]
    ds_read_b128 v[48:51], v3 offset:28672
    ds_read_b128 v[52:55], v3 offset:29696
    ds_read_b128 v[56:59], v3 offset:30720
    ds_read_b128 v[60:63], v3 offset:31744
    v_and_b32_dpp v32, v29, v4 row_newbcast:8 row_mask:0xf bank_mask:0xf
    v_and_b32_dpp v33, v29, v5 row_newbcast:8 row_mask:0xf bank_mask:0xf
    v_and_b32_dpp v34, v29, v6 row_newbcast:8 row_mask:0xf bank_mask:0xf
    v_and_b32_dpp v35, v29, v7 row_newbcast:8 row_mask:0xf bank_mask:0xf
    v_and_b32_dpp v36, v29, v4 row_newbcast:12 row_mask:0xf bank_mask:0xf
    v_and_b32_dpp v37, v29, v5 row_newbcast:12 row_mask:0xf bank_mask:0xf
    v_and_b32_dpp v38, v29, v6 row_newbcast:12 row_mask:0xf bank_mask:0xf
    v_and_b32_dpp v39, v29, v7 row_newbcast:12 row_mask:0xf bank_mask:0xf
    s_waitcnt lgkmcnt(2)
    v_mfma_f32_16x16x32_bf16 v[16:19], v[32:35], v[48:51], v[16:19]
    v_mfma_f32_16x16x32_bf16 v[20:23], v[32:35], v[52:55], v[20:23]
    s_waitcnt lgkmcnt(0)
    v_mfma_f32_16x16x32_bf16 v[16:19], v[36:39], v[56:59], v[16:19]
    v_mfma_f32_16x16x32_bf16 v[20:23], v[36:39], v[60:63], v[20:23]
    v_mfma_f32_16x16x32_bf16 v[32:35], v[192:195], v[8:11], 0
    v_mfma_f32_16x16x32_bf16 v[36:39], v[200:203], v[8:11], 0
    v_mfma_f32_16x16x32_bf16 v[40:43], v[208:211], v[8:11], 0
    v_mfma_f32_16x16x32_bf16 v[44:47], v[216:219], v[8:11], 0
    v_mfma_f32_16x16x32_bf16 v[32:35], v[196:199], v[12:15], v[32:35]
    v_mfma_f32_16x16x32_bf16 v[36:39], v[204:207], v[12:15], v[36:39]
    v_mfma_f32_16x16x32_bf16 v[40:43], v[212:215], v[12:15], v[40:43]
    v_mfma_f32_16x16x32_bf16 v[44:47], v[220:223], v[12:15], v[44:47]
    s_nop 7
    v_mov_b32_dpp v32, v32 quad_perm:[0,0,0,0] row_mask:0xf bank_mask:0xf
    v_mov_b32_dpp v36, v36 quad_perm:[0,0,0,0] row_mask:0xf bank_mask:0xf
    v_mov_b32_dpp v40, v40 quad_perm:[0,0,0,0] row_mask:0xf bank_mask:0xf
    v_mov_b32_dpp v44, v44 quad_perm:[0,0,0,0] row_mask:0xf bank_mask:0xf
    v_add_f32_dpp v32, v33, v32 quad_perm:[1,1,1,1] row_mask:0xf bank_mask:0xf
    v_add_f32_dpp v36, v37, v36 quad_perm:[1,1,1,1] row_mask:0xf bank_mask:0xf
    v_add_f32_dpp v40, v41, v40 quad_perm:[1,1,1,1] row_mask:0xf bank_mask:0xf
    v_add_f32_dpp v44, v45, v44 quad_perm:[1,1,1,1] row_mask:0xf bank_mask:0xf
    v_add_f32_dpp v32, v34, v32 quad_perm:[2,2,2,2] row_mask:0xf bank_mask:0xf
    v_add_f32_dpp v36, v38, v36 quad_perm:[2,2,2,2] row_mask:0xf bank_mask:0xf
    v_add_f32_dpp v40, v42, v40 quad_perm:[2,2,2,2] row_mask:0xf bank_mask:0xf
    v_add_f32_dpp v44, v46, v44 quad_perm:[2,2,2,2] row_mask:0xf bank_mask:0xf
    v_add_f32_dpp v27, v35, v32 quad_perm:[3,3,3,3] row_mask:0xf bank_mask:0x1
    v_add_f32_dpp v27, v39, v36 quad_perm:[3,3,3,3] row_mask:0xf bank_mask:0x2
    v_add_f32_dpp v27, v43, v40 quad_perm:[3,3,3,3] row_mask:0xf bank_mask:0x4
    v_add_f32_dpp v27, v47, v44 quad_perm:[3,3,3,3] row_mask:0xf bank_mask:0x8
    v_cvt_pk_bf16_f32 v27, v27, v27
    v_and_b32 v27, 0xffff0000, v27
    v_cmp_gt_f32 vcc, v27, v24
    s_cbranch_vccz SK_75
    s_swappc_b64 s[50:51], s[48:49]
SK_75:
    v_fma_f32 v28, v27, s53, -v25
    v_exp_f32 v28, v28
    s_nop 0
    v_add_f32 v26, v26, v28
    v_cvt_pk_bf16_f32 v29, v28, v28
    s_nop 1
    v_and_b32_dpp v32, v29, v4 row_newbcast:0 row_mask:0xf bank_mask:0xf
    v_and_b32_dpp v33, v29, v5 row_newbcast:0 row_mask:0xf bank_mask:0xf
    v_and_b32_dpp v34, v29, v6 row_newbcast:0 row_mask:0xf bank_mask:0xf
    v_and_b32_dpp v35, v29, v7 row_newbcast:0 row_mask:0xf bank_mask:0xf
    v_and_b32_dpp v36, v29, v4 row_newbcast:4 row_mask:0xf bank_mask:0xf
    v_and_b32_dpp v37, v29, v5 row_newbcast:4 row_mask:0xf bank_mask:0xf
    v_and_b32_dpp v38, v29, v6 row_newbcast:4 row_mask:0xf bank_mask:0xf
    v_and_b32_dpp v39, v29, v7 row_newbcast:4 row_mask:0xf bank_mask:0xf
    v_mfma_f32_16x16x32_bf16 v[16:19], v[32:35], v[224:227], v[16:19]
    v_mfma_f32_16x16x32_bf16 v[20:23], v[32:35], v[228:231], v[20:23]
    v_and_b32_dpp v32, v29, v4 row_newbcast:8 row_mask:0xf bank_mask:0xf
    v_and_b32_dpp v33, v29, v5 row_newbcast:8 row_mask:0xf bank_mask:0xf
    v_and_b32_dpp v34, v29, v6 row_newbcast:8 row_mask:0xf bank_mask:0xf
    v_and_b32_dpp v35, v29, v7 row_newbcast:8 row_mask:0xf bank_mask:0xf
    v_mfma_f32_16x16x32_bf16 v[16:19], v[36:39], v[232:235], v[16:19]
    v_mfma_f32_16x16x32_bf16 v[20:23], v[36:39], v[236:239], v[20:23]
    v_and_b32_dpp v36, v29, v4 row_newbcast:12 row_mask:0xf bank_mask:0xf
    v_and_b32_dpp v37, v29, v5 row_newbcast:12 row_mask:0xf bank_mask:0xf
    v_and_b32_dpp v38, v29, v6 row_newbcast:12 row_mask:0xf bank_mask:0xf
    v_and_b32_dpp v39, v29, v7 row_newbcast:12 row_mask:0xf bank_mask:0xf
    v_mfma_f32_16x16x32_bf16 v[16:19], v[32:35], v[240:243], v[16:19]
    v_mfma_f32_16x16x32_bf16 v[20:23], v[32:35], v[244:247], v[20:23]
    v_mfma_f32_16x16x32_bf16 v[16:19], v[36:39], v[248:251], v[16:19]
    v_mfma_f32_16x16x32_bf16 v[20:23], v[36:39], v[252:255], v[20:23]
    v_mfma_f32_16x16x32_bf16 v[32:35], a[0:3], v[8:11], 0
    v_mfma_f32_16x16x32_bf16 v[36:39], a[8:11], v[8:11], 0
    v_mfma_f32_16x16x32_bf16 v[40:43], a[16:19], v[8:11], 0
    v_mfma_f32_16x16x32_bf16 v[44:47], a[24:27], v[8:11], 0
    v_mfma_f32_16x16x32_bf16 v[32:35], a[4:7], v[12:15], v[32:35]
    v_mfma_f32_16x16x32_bf16 v[36:39], a[12:15], v[12:15], v[36:39]
    v_mfma_f32_16x16x32_bf16 v[40:43], a[20:23], v[12:15], v[40:43]
    v_mfma_f32_16x16x32_bf16 v[44:47], a[28:31], v[12:15], v[44:47]
    s_nop 7
    v_mov_b32_dpp v32, v32 quad_perm:[0,0,0,0] row_mask:0xf bank_mask:0xf
    v_mov_b32_dpp v36, v36 quad_perm:[0,0,0,0] row_mask:0xf bank_mask:0xf
    v_mov_b32_dpp v40, v40 quad_perm:[0,0,0,0] row_mask:0xf bank_mask:0xf
    v_mov_b32_dpp v44, v44 quad_perm:[0,0,0,0] row_mask:0xf bank_mask:0xf
    v_add_f32_dpp v32, v33, v32 quad_perm:[1,1,1,1] row_mask:0xf bank_mask:0xf
    v_add_f32_dpp v36, v37, v36 quad_perm:[1,1,1,1] row_mask:0xf bank_mask:0xf
    v_add_f32_dpp v40, v41, v40 quad_perm:[1,1,1,1] row_mask:0xf bank_mask:0xf
    v_add_f32_dpp v44, v45, v44 quad_perm:[1,1,1,1] row_mask:0xf bank_mask:0xf
    v_add_f32_dpp v32, v34, v32 quad_perm:[2,2,2,2] row_mask:0xf bank_mask:0xf
    v_add_f32_dpp v36, v38, v36 quad_perm:[2,2,2,2] row_mask:0xf bank_mask:0xf
    v_add_f32_dpp v40, v42, v40 quad_perm:[2,2,2,2] row_mask:0xf bank_mask:0xf
    v_add_f32_dpp v44, v46, v44 quad_perm:[2,2,2,2] row_mask:0xf bank_mask:0xf
    v_add_f32_dpp v27, v35, v32 quad_perm:[3,3,3,3] row_mask:0xf bank_mask:0x1
    v_add_f32_dpp v27, v39, v36 quad_perm:[3,3,3,3] row_mask:0xf bank_mask:0x2
    v_add_f32_dpp v27, v43, v40 quad_perm:[3,3,3,3] row_mask:0xf bank_mask:0x4
    v_add_f32_dpp v27, v47, v44 quad_perm:[3,3,3,3] row_mask:0xf bank_mask:0x8
    v_cvt_pk_bf16_f32 v27, v27, v27
    v_and_b32 v27, 0xffff0000, v27
    v_cmp_gt_f32 vcc, v27, v24
    s_cbranch_vccz SK_76
    s_swappc_b64 s[50:51], s[48:49]
SK_76:
    v_fma_f32 v28, v27, s53, -v25
    v_exp_f32 v28, v28
    s_nop 0
    v_add_f32 v26, v26, v28
    v_cvt_pk_bf16_f32 v29, v28, v28
    s_nop 1
    v_and_b32_dpp v32, v29, v4 row_newbcast:0 row_mask:0xf bank_mask:0xf
    v_and_b32_dpp v33, v29, v5 row_newbcast:0 row_mask:0xf bank_mask:0xf
    v_and_b32_dpp v34, v29, v6 row_newbcast:0 row_mask:0xf bank_mask:0xf
    v_and_b32_dpp v35, v29, v7 row_newbcast:0 row_mask:0xf bank_mask:0xf
    v_and_b32_dpp v36, v29, v4 row_newbcast:4 row_mask:0xf bank_mask:0xf
    v_and_b32_dpp v37, v29, v5 row_newbcast:4 row_mask:0xf bank_mask:0xf
    v_and_b32_dpp v38, v29, v6 row_newbcast:4 row_mask:0xf bank_mask:0xf
    v_and_b32_dpp v39, v29, v7 row_newbcast:4 row_mask:0xf bank_mask:0xf
    v_mfma_f32_16x16x32_bf16 v[16:19], v[32:35], a[32:35], v[16:19]
    v_mfma_f32_16x16x32_bf16 v[20:23], v[32:35], a[36:39], v[20:23]
    v_and_b32_dpp v32, v29, v4 row_newbcast:8 row_mask:0xf bank_mask:0xf
    v_and_b32_dpp v33, v29, v5 row_newbcast:8 row_mask:0xf bank_mask:0xf
    v_and_b32_dpp v34, v29, v6 row_newbcast:8 row_mask:0xf bank_mask:0xf
    v_and_b32_dpp v35, v29, v7 row_newbcast:8 row_mask:0xf bank_mask:0xf
    v_mfma_f32_16x16x32_bf16 v[16:19], v[36:39], a[40:43], v[16:19]
    v_mfma_f32_16x16x32_bf16 v[20:23], v[36:39], a[44:47], v[20:23]
    v_and_b32_dpp v36, v29, v4 row_newbcast:12 row_mask:0xf bank_mask:0xf
    v_and_b32_dpp v37, v29, v5 row_newbcast:12 row_mask:0xf bank_mask:0xf
    v_and_b32_dpp v38, v29, v6 row_newbcast:12 row_mask:0xf bank_mask:0xf
    v_and_b32_dpp v39, v29, v7 row_newbcast:12 row_mask:0xf bank_mask:0xf
    v_mfma_f32_16x16x32_bf16 v[16:19], v[32:35], a[48:51], v[16:19]
    v_mfma_f32_16x16x32_bf16 v[20:23], v[32:35], a[52:55], v[20:23]
    v_mfma_f32_16x16x32_bf16 v[16:19], v[36:39], a[56:59], v[16:19]
    v_mfma_f32_16x16x32_bf16 v[20:23], v[36:39], a[60:63], v[20:23]
    s_setpc_b64 s[70:71]
HELDB:
    v_mfma_f32_16x16x32_bf16 v[32:35], a[64:67], v[8:11], 0
    v_mfma_f32_16x16x32_bf16 v[36:39], a[72:75], v[8:11], 0
    v_mfma_f32_16x16x32_bf16 v[40:43], a[80:83], v[8:11], 0
    v_mfma_f32_16x16x32_bf16 v[44:47], a[88:91], v[8:11], 0
    v_mfma_f32_16x16x32_bf16 v[32:35], a[68:71], v[12:15], v[32:35]
    v_mfma_f32_16x16x32_bf16 v[36:39], a[76:79], v[12:15], v[36:39]
    v_mfma_f32_16x16x32_bf16 v[40:43], a[84:87], v[12:15], v[40:43]
    v_mfma_f32_16x16x32_bf16 v[44:47], a[92:95], v[12:15], v[44:47]
    s_nop 7
    v_mov_b32_dpp v32, v32 quad_perm:[0,0,0,0] row_mask:0xf bank_mask:0xf
    v_mov_b32_dpp v36, v36 quad_perm:[0,0,0,0] row_mask:0xf bank_mask:0xf
    v_mov_b32_dpp v40, v40 quad_perm:[0,0,0,0] row_mask:0xf bank_mask:0xf
    v_mov_b32_dpp v44, v44 quad_perm:[0,0,0,0] row_mask:0xf bank_mask:0xf
    v_add_f32_dpp v32, v33, v32 quad_perm:[1,1,1,1] row_mask:0xf bank_mask:0xf
    v_add_f32_dpp v36, v37, v36 quad_perm:[1,1,1,1] row_mask:0xf bank_mask:0xf
    v_add_f32_dpp v40, v41, v40 quad_perm:[1,1,1,1] row_mask:0xf bank_mask:0xf
    v_add_f32_dpp v44, v45, v44 quad_perm:[1,1,1,1] row_mask:0xf bank_mask:0xf
    v_add_f32_dpp v32, v34, v32 quad_perm:[2,2,2,2] row_mask:0xf bank_mask:0xf
    v_add_f32_dpp v36, v38, v36 quad_perm:[2,2,2,2] row_mask:0xf bank_mask:0xf
    v_add_f32_dpp v40, v42, v40 quad_perm:[2,2,2,2] row_mask:0xf bank_mask:0xf
    v_add_f32_dpp v44, v46, v44 quad_perm:[2,2,2,2] row_mask:0xf bank_mask:0xf
    v_add_f32_dpp v27, v35, v32 quad_perm:[3,3,3,3] row_mask:0xf bank_mask:0x1
    v_add_f32_dpp v27, v39, v36 quad_perm:[3,3,3,3] row_mask:0xf bank_mask:0x2
    v_add_f32_dpp v27, v43, v40 quad_perm:[3,3,3,3] row_mask:0xf bank_mask:0x4
    v_add_f32_dpp v27, v47, v44 quad_perm:[3,3,3,3] row_mask:0xf bank_mask:0x8
    v_cvt_pk_bf16_f32 v27, v27, v27
    v_and_b32 v27, 0xffff0000, v27
    v_cmp_gt_f32 vcc, v27, v24
    s_cbranch_vccz SK_77
    s_swappc_b64 s[50:51], s[48:49]
SK_77:
    v_fma_f32 v28, v27, s53, -v25
    v_exp_f32 v28, v28
    s_nop 0
    v_add_f32 v26, v26, v28
    v_cvt_pk_bf16_f32 v29, v28, v28
    s_nop 1
    v_and_b32_dpp v32, v29, v4 row_newbcast:0 row_mask:0xf bank_mask:0xf
    v_and_b32_dpp v33, v29, v5 row_newbcast:0 row_mask:0xf bank_mask:0xf
    v_and_b32_dpp v34, v29, v6 row_newbcast:0 row_mask:0xf bank_mask:0xf
    v_and_b32_dpp v35, v29, v7 row_newbcast:0 row_mask:0xf bank_mask:0xf
    v_and_b32_dpp v36, v29, v4 row_newbcast:4 row_mask:0xf bank_mask:0xf
    v_and_b32_dpp v37, v29, v5 row_newbcast:4 row_mask:0xf bank_mask:0xf
    v_and_b32_dpp v38, v29, v6 row_newbcast:4 row_mask:0xf bank_mask:0xf
    v_and_b32_dpp v39, v29, v7 row_newbcast:4 row_mask:0xf bank_mask:0xf
    v_mfma_f32_16x16x32_bf16 v[16:19], v[32:35], a[96:99], v[16:19]
    v_mfma_f32_16x16x32_bf16 v[20:23], v[32:35], a[100:103], v[20:23]
    v_and_b32_dpp v32, v29, v4 row_newbcast:8 row_mask:0xf bank_mask:0xf
    v_and_b32_dpp v33, v29, v5 row_newbcast:8 row_mask:0xf bank_mask:0xf
    v_and_b32_dpp v34, v29, v6 row_newbcast:8 row_mask:0xf bank_mask:0xf
    v_and_b32_dpp v35, v29, v7 row_newbcast:8 row_mask:0xf bank_mask:0xf
    v_mfma_f32_16x16x32_bf16 v[16:19], v[36:39], a[104:107], v[16:19]
    v_mfma_f32_16x16x32_bf16 v[20:23], v[36:39], a[108:111], v[20:23]
    v_and_b32_dpp v36, v29, v4 row_newbcast:12 row_mask:0xf bank_mask:0xf
    v_and_b32_dpp v37, v29, v5 row_newbcast:12 row_mask:0xf bank_mask:0xf
    v_and_b32_dpp v38, v29, v6 row_newbcast:12 row_mask:0xf bank_mask:0xf
    v_and_b32_dpp v39, v29, v7 row_newbcast:12 row_mask:0xf bank_mask:0xf
    v_mfma_f32_16x16x32_bf16 v[16:19], v[32:35], a[112:115], v[16:19]
    v_mfma_f32_16x16x32_bf16 v[20:23], v[32:35], a[116:119], v[20:23]
    v_mfma_f32_16x16x32_bf16 v[16:19], v[36:39], a[120:123], v[16:19]
    v_mfma_f32_16x16x32_bf16 v[20:23], v[36:39], a[124:127], v[20:23]
    v_mfma_f32_16x16x32_bf16 v[32:35], a[128:131], v[8:11], 0
    v_mfma_f32_16x16x32_bf16 v[36:39], a[136:139], v[8:11], 0
    v_mfma_f32_16x16x32_bf16 v[40:43], a[144:147], v[8:11], 0
    v_mfma_f32_16x16x32_bf16 v[44:47], a[152:155], v[8:11], 0
    v_mfma_f32_16x16x32_bf16 v[32:35], a[132:135], v[12:15], v[32:35]
    v_mfma_f32_16x16x32_bf16 v[36:39], a[140:143], v[12:15], v[36:39]
    v_mfma_f32_16x16x32_bf16 v[40:43], a[148:151], v[12:15], v[40:43]
    v_mfma_f32_16x16x32_bf16 v[44:47], a[156:159], v[12:15], v[44:47]
    s_nop 7
    v_mov_b32_dpp v32, v32 quad_perm:[0,0,0,0] row_mask:0xf bank_mask:0xf
    v_mov_b32_dpp v36, v36 quad_perm:[0,0,0,0] row_mask:0xf bank_mask:0xf
    v_mov_b32_dpp v40, v40 quad_perm:[0,0,0,0] row_mask:0xf bank_mask:0xf
    v_mov_b32_dpp v44, v44 quad_perm:[0,0,0,0] row_mask:0xf bank_mask:0xf
    v_add_f32_dpp v32, v33, v32 quad_perm:[1,1,1,1] row_mask:0xf bank_mask:0xf
    v_add_f32_dpp v36, v37, v36 quad_perm:[1,1,1,1] row_mask:0xf bank_mask:0xf
    v_add_f32_dpp v40, v41, v40 quad_perm:[1,1,1,1] row_mask:0xf bank_mask:0xf
    v_add_f32_dpp v44, v45, v44 quad_perm:[1,1,1,1] row_mask:0xf bank_mask:0xf
    v_add_f32_dpp v32, v34, v32 quad_perm:[2,2,2,2] row_mask:0xf bank_mask:0xf
    v_add_f32_dpp v36, v38, v36 quad_perm:[2,2,2,2] row_mask:0xf bank_mask:0xf
    v_add_f32_dpp v40, v42, v40 quad_perm:[2,2,2,2] row_mask:0xf bank_mask:0xf
    v_add_f32_dpp v44, v46, v44 quad_perm:[2,2,2,2] row_mask:0xf bank_mask:0xf
    v_add_f32_dpp v27, v35, v32 quad_perm:[3,3,3,3] row_mask:0xf bank_mask:0x1
    v_add_f32_dpp v27, v39, v36 quad_perm:[3,3,3,3] row_mask:0xf bank_mask:0x2
    v_add_f32_dpp v27, v43, v40 quad_perm:[3,3,3,3] row_mask:0xf bank_mask:0x4
    v_add_f32_dpp v27, v47, v44 quad_perm:[3,3,3,3] row_mask:0xf bank_mask:0x8
    v_cvt_pk_bf16_f32 v27, v27, v27
    v_and_b32 v27, 0xffff0000, v27
    v_cmp_gt_f32 vcc, v27, v24
    s_cbranch_vccz SK_78
    s_swappc_b64 s[50:51], s[48:49]
SK_78:
    v_fma_f32 v28, v27, s53, -v25
    v_exp_f32 v28, v28
    s_nop 0
    v_add_f32 v26, v26, v28
    v_cvt_pk_bf16_f32 v29, v28, v28
    s_nop 1
    v_and_b32_dpp v32, v29, v4 row_newbcast:0 row_mask:0xf bank_mask:0xf
    v_and_b32_dpp v33, v29, v5 row_newbcast:0 row_mask:0xf bank_mask:0xf
    v_and_b32_dpp v34, v29, v6 row_newbcast:0 row_mask:0xf bank_mask:0xf
    v_and_b32_dpp v35, v29, v7 row_newbcast:0 row_mask:0xf bank_mask:0xf
    v_and_b32_dpp v36, v29, v4 row_newbcast:4 row_mask:0xf bank_mask:0xf
    v_and_b32_dpp v37, v29, v5 row_newbcast:4 row_mask:0xf bank_mask:0xf
    v_and_b32_dpp v38, v29, v6 row_newbcast:4 row_mask:0xf bank_mask:0xf
    v_and_b32_dpp v39, v29, v7 row_newbcast:4 row_mask:0xf bank_mask:0xf
    v_mfma_f32_16x16x32_bf16 v[16:19], v[32:35], a[160:163], v[16:19]
    v_mfma_f32_16x16x32_bf16 v[20:23], v[32:35], a[164:167], v[20:23]
    v_and_b32_dpp v32, v29, v4 row_newbcast:8 row_mask:0xf bank_mask:0xf
    v_and_b32_dpp v33, v29, v5 row_newbcast:8 row_mask:0xf bank_mask:0xf
    v_and_b32_dpp v34, v29, v6 row_newbcast:8 row_mask:0xf bank_mask:0xf
    v_and_b32_dpp v35, v29, v7 row_newbcast:8 row_mask:0xf bank_mask:0xf
    v_mfma_f32_16x16x32_bf16 v[16:19], v[36:39], a[168:171], v[16:19]
    v_mfma_f32_16x16x32_bf16 v[20:23], v[36:39], a[172:175], v[20:23]
    v_and_b32_dpp v36, v29, v4 row_newbcast:12 row_mask:0xf bank_mask:0xf
    v_and_b32_dpp v37, v29, v5 row_newbcast:12 row_mask:0xf bank_mask:0xf
    v_and_b32_dpp v38, v29, v6 row_newbcast:12 row_mask:0xf bank_mask:0xf
    v_and_b32_dpp v39, v29, v7 row_newbcast:12 row_mask:0xf bank_mask:0xf
    v_mfma_f32_16x16x32_bf16 v[16:19], v[32:35], a[176:179], v[16:19]
    v_mfma_f32_16x16x32_bf16 v[20:23], v[32:35], a[180:183], v[20:23]
    v_mfma_f32_16x16x32_bf16 v[16:19], v[36:39], a[184:187], v[16:19]
    v_mfma_f32_16x16x32_bf16 v[20:23], v[36:39], a[188:191], v[20:23]
    v_mfma_f32_16x16x32_bf16 v[32:35], a[192:195], v[8:11], 0
    v_mfma_f32_16x16x32_bf16 v[36:39], a[200:203], v[8:11], 0
    v_mfma_f32_16x16x32_bf16 v[40:43], a[208:211], v[8:11], 0
    v_mfma_f32_16x16x32_bf16 v[44:47], a[216:219], v[8:11], 0
    v_mfma_f32_16x16x32_bf16 v[32:35], a[196:199], v[12:15], v[32:35]
    v_mfma_f32_16x16x32_bf16 v[36:39], a[204:207], v[12:15], v[36:39]
    v_mfma_f32_16x16x32_bf16 v[40:43], a[212:215], v[12:15], v[40:43]
    v_mfma_f32_16x16x32_bf16 v[44:47], a[220:223], v[12:15], v[44:47]
    s_nop 7
    v_mov_b32_dpp v32, v32 quad_perm:[0,0,0,0] row_mask:0xf bank_mask:0xf
    v_mov_b32_dpp v36, v36 quad_perm:[0,0,0,0] row_mask:0xf bank_mask:0xf
    v_mov_b32_dpp v40, v40 quad_perm:[0,0,0,0] row_mask:0xf bank_mask:0xf
    v_mov_b32_dpp v44, v44 quad_perm:[0,0,0,0] row_mask:0xf bank_mask:0xf
    v_add_f32_dpp v32, v33, v32 quad_perm:[1,1,1,1] row_mask:0xf bank_mask:0xf
    v_add_f32_dpp v36, v37, v36 quad_perm:[1,1,1,1] row_mask:0xf bank_mask:0xf
    v_add_f32_dpp v40, v41, v40 quad_perm:[1,1,1,1] row_mask:0xf bank_mask:0xf
    v_add_f32_dpp v44, v45, v44 quad_perm:[1,1,1,1] row_mask:0xf bank_mask:0xf
    v_add_f32_dpp v32, v34, v32 quad_perm:[2,2,2,2] row_mask:0xf bank_mask:0xf
    v_add_f32_dpp v36, v38, v36 quad_perm:[2,2,2,2] row_mask:0xf bank_mask:0xf
    v_add_f32_dpp v40, v42, v40 quad_perm:[2,2,2,2] row_mask:0xf bank_mask:0xf
    v_add_f32_dpp v44, v46, v44 quad_perm:[2,2,2,2] row_mask:0xf bank_mask:0xf
    v_add_f32_dpp v27, v35, v32 quad_perm:[3,3,3,3] row_mask:0xf bank_mask:0x1
    v_add_f32_dpp v27, v39, v36 quad_perm:[3,3,3,3] row_mask:0xf bank_mask:0x2
    v_add_f32_dpp v27, v43, v40 quad_perm:[3,3,3,3] row_mask:0xf bank_mask:0x4
    v_add_f32_dpp v27, v47, v44 quad_perm:[3,3,3,3] row_mask:0xf bank_mask:0x8
    v_cvt_pk_bf16_f32 v27, v27, v27
    v_and_b32 v27, 0xffff0000, v27
    v_cmp_gt_f32 vcc, v27, v24
    s_cbranch_vccz SK_79
    s_swappc_b64 s[50:51], s[48:49]
SK_79:
    v_fma_f32 v28, v27, s53, -v25
    v_exp_f32 v28, v28
    s_nop 0
    v_add_f32 v26, v26, v28
    v_cvt_pk_bf16_f32 v29, v28, v28
    s_nop 1
    v_and_b32_dpp v32, v29, v4 row_newbcast:0 row_mask:0xf bank_mask:0xf
    v_and_b32_dpp v33, v29, v5 row_newbcast:0 row_mask:0xf bank_mask:0xf
    v_and_b32_dpp v34, v29, v6 row_newbcast:0 row_mask:0xf bank_mask:0xf
    v_and_b32_dpp v35, v29, v7 row_newbcast:0 row_mask:0xf bank_mask:0xf
    v_and_b32_dpp v36, v29, v4 row_newbcast:4 row_mask:0xf bank_mask:0xf
    v_and_b32_dpp v37, v29, v5 row_newbcast:4 row_mask:0xf bank_mask:0xf
    v_and_b32_dpp v38, v29, v6 row_newbcast:4 row_mask:0xf bank_mask:0xf
    v_and_b32_dpp v39, v29, v7 row_newbcast:4 row_mask:0xf bank_mask:0xf
    v_mfma_f32_16x16x32_bf16 v[16:19], v[32:35], a[224:227], v[16:19]
    v_mfma_f32_16x16x32_bf16 v[20:23], v[32:35], a[228:231], v[20:23]
    v_and_b32_dpp v32, v29, v4 row_newbcast:8 row_mask:0xf bank_mask:0xf
    v_and_b32_dpp v33, v29, v5 row_newbcast:8 row_mask:0xf bank_mask:0xf
    v_and_b32_dpp v34, v29, v6 row_newbcast:8 row_mask:0xf bank_mask:0xf
    v_and_b32_dpp v35, v29, v7 row_newbcast:8 row_mask:0xf bank_mask:0xf
    v_mfma_f32_16x16x32_bf16 v[16:19], v[36:39], a[232:235], v[16:19]
    v_mfma_f32_16x16x32_bf16 v[20:23], v[36:39], a[236:239], v[20:23]
    v_and_b32_dpp v36, v29, v4 row_newbcast:12 row_mask:0xf bank_mask:0xf
    v_and_b32_dpp v37, v29, v5 row_newbcast:12 row_mask:0xf bank_mask:0xf
    v_and_b32_dpp v38, v29, v6 row_newbcast:12 row_mask:0xf bank_mask:0xf
    v_and_b32_dpp v39, v29, v7 row_newbcast:12 row_mask:0xf bank_mask:0xf
    v_mfma_f32_16x16x32_bf16 v[16:19], v[32:35], a[240:243], v[16:19]
    v_mfma_f32_16x16x32_bf16 v[20:23], v[32:35], a[244:247], v[20:23]
    v_mfma_f32_16x16x32_bf16 v[16:19], v[36:39], a[248:251], v[16:19]
    v_mfma_f32_16x16x32_bf16 v[20:23], v[36:39], a[252:255], v[20:23]
    s_setpc_b64 s[70:71]
CODE_END:
    s_endpgm
    s_endpgm
    s_endpgm
    s_endpgm
    s_endpgm
    s_endpgm
    s_endpgm
    s_endpgm
    s_endpgm
    s_endpgm
    s_endpgm
    s_endpgm
    s_endpgm
    s_endpgm
    s_endpgm
    s_endpgm
    s_endpgm
    s_endpgm
    s_endpgm
    s_endpgm
    s_endpgm
    s_endpgm
    s_endpgm
    s_endpgm
    s_endpgm
    s_endpgm
    s_endpgm
    s_endpgm
    s_endpgm
    s_endpgm
    s_endpgm
    s_endpgm
    s_endpgm
    s_endpgm
    s_endpgm
    s_endpgm
    s_endpgm
    s_endpgm
    s_endpgm
    s_endpgm
    s_endpgm
    s_endpgm
    s_endpgm
    s_endpgm
    s_endpgm
    s_endpgm
    s_endpgm
    s_endpgm
    s_endpgm
    s_endpgm
    s_endpgm
    s_endpgm
    s_endpgm
    s_endpgm
    s_endpgm
    s_endpgm
    s_endpgm
    s_endpgm
    s_endpgm
    s_endpgm
    s_endpgm
    s_endpgm
    s_endpgm
    s_endpgm
.section .rodata,"a"
.p2align 6
.amdhsa_kernel interleave_layers__mha_block_cached__glu_gated_swiglu__decode_kernel
  .amdhsa_next_free_vgpr 512
  .amdhsa_next_free_sgpr 102
  .amdhsa_accum_offset 256
  .amdhsa_group_segment_fixed_size 0
  .amdhsa_kernarg_size 96
  .amdhsa_user_sgpr_count 2
  .amdhsa_user_sgpr_kernarg_segment_ptr 1
  .amdhsa_system_sgpr_workgroup_id_x 1
  .amdhsa_float_denorm_mode_32 3
.end_amdhsa_kernel
```
